```python
import torch

def _softmax(x, axis=-1):
    return torch.softmax(x, dim=axis)
def _gelu(x):
    return torch.nn.functional.gelu(x, approximate="tanh")
def _silu(x):
    return torch.nn.functional.silu(x)
def _sigmoid(x):
    return torch.sigmoid(x)
def _layernorm(x, axis=-1, eps=1e-5):
    m = x.mean(dim=axis, keepdim=True)
    v = x.var(dim=axis, keepdim=True, unbiased=False)
    return (x - m) / torch.sqrt(v + eps)
def _scatter_add(tgt, idx, src, axis=0):
    return tgt.clone().index_add_(axis, idx, src)
def _segment_sum(src, seg, n):
    out = torch.zeros((n,) + src.shape[1:], dtype=src.dtype)
    return out.index_add_(0, seg, src)
def _pad(x, pw):
    flat = tuple(v for pair in reversed(pw) for v in pair)
    return torch.nn.functional.pad(x, flat)

kernel_name = 'standalone__window_attn_swin__vision'

def setup_inputs():

    _w = (lambda a: (lambda t: t.to(torch.bfloat16) if t.is_floating_point() else t)(torch.as_tensor(a)))
    H = W = 384
    C = 192
    ws = 8
    nh = 4
    shift = ws // 2
    coords = torch.stack(torch.meshgrid(torch.arange(ws), torch.arange(ws), indexing='ij'), 0).reshape(2, -1)
    rel = coords[:, :, None] - coords[:, None, :]
    rel[0] += ws - 1
    rel[1] += ws - 1
    rel[0] *= 2 * ws - 1
    rp_idx = rel.sum(0).to(torch.int64)
    img_mask = torch.zeros((1, H, W, 1), dtype=float)
    cnt = 0
    for hs in (slice(0, H - ws), slice(H - ws, H - shift), slice(H - shift, H)):
        for vs in (slice(0, W - ws), slice(W - ws, W - shift), slice(W - shift, W)):
            img_mask[:, hs, vs, :] = cnt
            cnt += 1
    mw = img_mask.reshape(1, H // ws, ws, W // ws, ws, 1).permute(0, 1, 3, 2, 4, 5).reshape(-1, ws * ws)
    am = mw[:, :, None] - mw[:, None, :]
    attn_mask = torch.where(am != 0, -100.0, 0.0).to(float)
    return {
        "x": _w((lambda *s: torch.randn(*s, dtype=torch.bfloat16) * 1.6)(1, H, W, C)),
        "wqkv": _w((lambda *s: torch.randn(*s, dtype=torch.bfloat16) * 1.6)(C, 3 * C) * 0.02),
        "wo": _w((lambda *s: torch.randn(*s, dtype=torch.bfloat16) * 0.05)(C, C) * 0.02),
        "rpb": _w((lambda *s: torch.randn(*s, dtype=torch.bfloat16) * 0.2)((2 * ws - 1) * (2 * ws - 1), nh)),
        "rp_idx": _w(rp_idx),
        "attn_mask": _w(attn_mask),
    }

def reference(x, wqkv, wo, rpb, rp_idx, attn_mask):
    B, H, W, C = x.shape
    N = rp_idx.shape[0]
    ws = int(round(N ** 0.5))
    nh = rpb.shape[-1]
    hd = C // nh
    shift = ws // 2
    xs = torch.roll(x, (-shift, -shift), (1, 2))
    nWh = H // ws
    nWw = W // ws
    xw = (lambda x, *d: x.permute(*d))(xs.reshape(B, nWh, ws, nWw, ws, C), 0, 1, 3, 2, 4, 5).reshape(B * nWh * nWw, N, C)
    qkv = (lambda x, *d: x.permute(*d))(torch.einsum('wnc,cd->wnd', xw, wqkv).reshape(-1, N, 3, nh, hd), 2, 0, 3, 1, 4)
    q, k, v = qkv[0], qkv[1], qkv[2]
    attn = torch.einsum('whid,whjd->whij', q, k) * (hd ** -0.5)
    bias = (lambda x, *d: x.permute(*d))(rpb[rp_idx.reshape(-1)].reshape(N, N, nh), 2, 0, 1)
    attn = attn + bias[None, :, :, :]
    attn = (attn.reshape(B, nWh * nWw, nh, N, N) + attn_mask[None, :, None, :, :]).reshape(-1, nh, N, N)
    attn = _softmax(attn, axis=-1)
    out = (lambda x, *d: x.permute(*d))(torch.einsum('whij,whjd->whid', attn, v), 0, 2, 1, 3).reshape(-1, N, C)
    out = torch.einsum('wnc,cd->wnd', out, wo)
    out = (lambda x, *d: x.permute(*d))(out.reshape(B, nWh, nWw, ws, ws, C), 0, 1, 3, 2, 4, 5).reshape(B, H, W, C)
    return torch.roll(out, (shift, shift), (1, 2))
```

```asm
; @launch grid=(256,1,1) block=(512,1,1) lds=160512
.amdgcn_target "amdgcn-amd-amdhsa--gfx950"
.text
.globl standalone__window_attn_swin__vision_kernel
.p2align 8
.type standalone__window_attn_swin__vision_kernel,@function
standalone__window_attn_swin__vision_kernel:
    s_cmp_ge_u32 s2, 256
    s_cbranch_scc1 L_END
    s_load_dwordx2 s[8:9], s[0:1], 0
    s_load_dwordx2 s[16:17], s[0:1], 8
    s_load_dwordx2 s[20:21], s[0:1], 16
    s_load_dwordx2 s[24:25], s[0:1], 24
    s_load_dwordx2 s[12:13], s[0:1], 48
    v_lshrrev_b32 v1, 6, v0
    v_and_b32 v0, 63, v0
    v_readfirstlane_b32 s3, v1
    s_mov_b32 s10, 56623104
    s_mov_b32 s11, 0x00020000
    s_mov_b32 s14, 56623104
    s_mov_b32 s15, 0x00020000
    s_mov_b32 s18, 221184
    s_mov_b32 s19, 0x00020000
    s_mov_b32 s22, 73728
    s_mov_b32 s23, 0x00020000
    s_mov_b32 s26, 1800
    s_mov_b32 s27, 0x00020000
    s_and_b32 s4, s3, 3
    s_mov_b32 s7, 0
    s_cmp_ge_u32 s3, 4
    s_cbranch_scc1 L_B
    s_setprio 3
    s_bfe_u32 s28, s2, 0x50003
    s_mul_i32 s29, s28, 6912
    s_mul_i32 s30, s4, 1792
    s_add_u32 s29, s29, s30
    s_mul_i32 s28, s28, 2304
    s_mul_i32 s30, s4, 640
    s_add_u32 s28, s28, s30
    v_lshlrev_b32 v20, 7, v0
    s_mov_b64 exec, 0x3fff
    s_waitcnt lgkmcnt(0)
    buffer_load_dword v12, v20, s[16:19], s29 offen
    s_mov_b64 exec, 0x1f
    buffer_load_dword v13, v20, s[20:23], s28 offen
    s_mov_b64 exec, -1
    s_setprio 0
    s_lshl_b32 s31, s4, 6
    v_add_u32 v80, s31, v0
    v_mul_u32_u24 v81, 43691, v80
    v_lshrrev_b32 v81, 21, v81
    v_mul_u32_u24 v82, 48, v81
    v_sub_u32 v82, v80, v82
    v_mul_u32_u24 v81, 15, v81
    v_add_u32 v81, 14, v81
    v_lshrrev_b32 v83, 2, v82
    v_sub_u32 v81, v81, v83
    v_and_b32 v83, 3, v82
    v_sub_u32 v81, v81, v83
    v_lshlrev_b32 v86, 3, v81
    buffer_load_dwordx2 v[60:61], v86, s[24:27], 0 offen
    v_add_u32 v80, s31, v0
    v_add_u32 v80, 256, v80
    v_mul_u32_u24 v81, 43691, v80
    v_lshrrev_b32 v81, 21, v81
    v_mul_u32_u24 v82, 48, v81
    v_sub_u32 v82, v80, v82
    v_mul_u32_u24 v81, 15, v81
    v_add_u32 v81, 14, v81
    v_lshrrev_b32 v83, 2, v82
    v_sub_u32 v81, v81, v83
    v_and_b32 v83, 3, v82
    v_sub_u32 v81, v81, v83
    v_lshlrev_b32 v87, 3, v81
    buffer_load_dwordx2 v[62:63], v87, s[24:27], 0 offen
    v_add_u32 v80, s31, v0
    v_add_u32 v80, 512, v80
    v_mul_u32_u24 v81, 43691, v80
    v_lshrrev_b32 v81, 21, v81
    v_mul_u32_u24 v82, 48, v81
    v_sub_u32 v82, v80, v82
    v_mul_u32_u24 v81, 15, v81
    v_add_u32 v81, 14, v81
    v_lshrrev_b32 v83, 2, v82
    v_sub_u32 v81, v81, v83
    v_and_b32 v83, 3, v82
    v_sub_u32 v81, v81, v83
    v_lshlrev_b32 v88, 3, v81
    buffer_load_dwordx2 v[64:65], v88, s[24:27], 0 offen
    s_lshl_b32 s30, s4, 8
    s_add_u32 s30, s30, 99840
    v_lshlrev_b32 v66, 2, v0
    v_add_u32 v66, s30, v66
    s_mov_b32 s6, 0x3e553b95
    s_mov_b32 s5, 0
    v_lshrrev_b32 v20, 5, v0
    v_bfe_u32 v21, v0, 2, 2
    v_lshl_add_u32 v22, v20, 3, v21
    v_mul_u32_u24 v22, 768, v22
    v_bfe_u32 v23, v0, 4, 1
    v_mul_u32_u24 v23, 384, v23
    v_add_u32 v22, v22, v23
    v_and_b32 v23, 3, v0
    v_lshl_add_u32 v22, v23, 3, v22
    v_add_u32 v22, 50176, v22
    s_mul_i32 s28, s4, 3
    s_add_u32 s29, s28, 0
    v_xor_b32 v23, s29, v21
    v_lshl_add_u32 v76, v23, 5, v22
    s_add_u32 s29, s28, 1
    v_xor_b32 v23, s29, v21
    v_lshl_add_u32 v77, v23, 5, v22
    s_add_u32 s29, s28, 2
    v_xor_b32 v23, s29, v21
    v_lshl_add_u32 v78, v23, 5, v22
    v_bfe_u32 v21, v0, 3, 2
    v_mul_u32_u24 v1, 3136, v21
    v_and_b32 v21, 7, v0
    v_mul_u32_u24 v21, 384, v21
    v_add_u32 v1, v1, v21
    v_bfe_u32 v21, v0, 1, 2
    v_xor_b32 v21, v21, v20
    v_lshl_add_u32 v1, v21, 4, v1
    v_xor_b32 v2, 32, v1
    v_bfe_u32 v21, v0, 2, 3
    v_sub_u32 v21, v21, v20
    v_add_u32 v21, 1, v21
    v_mul_u32_u24 v3, 192, v21
    v_and_b32 v21, 3, v0
    v_sub_u32 v21, 3, v21
    v_lshl_add_u32 v3, v21, 4, v3
    s_mul_i32 s30, s4, 2880
    s_add_u32 s30, s30, 99840
    v_add_u32 v3, s30, v3
    v_and_b32 v21, 31, v0
    v_lshlrev_b32 v21, 4, v21
    v_lshl_add_u32 v4, v20, 10, v21
    s_lshl_b32 s30, s4, 13
    s_add_u32 s30, s30, 111360
    v_add_u32 v4, s30, v4
    s_waitcnt vmcnt(0)
    v_lshlrev_b32 v84, 16, v60
    v_mul_f32 v84, 0x40ddb3d7, v84
    ds_write_b32 v66, v84 offset:0
    v_and_b32 v85, 0xffff0000, v60
    v_mul_f32 v85, 0x40ddb3d7, v85
    ds_write_b32 v66, v85 offset:2880
    v_lshlrev_b32 v86, 16, v61
    v_mul_f32 v86, 0x40ddb3d7, v86
    ds_write_b32 v66, v86 offset:5760
    v_and_b32 v87, 0xffff0000, v61
    v_mul_f32 v87, 0x40ddb3d7, v87
    ds_write_b32 v66, v87 offset:8640
    v_lshlrev_b32 v84, 16, v62
    v_mul_f32 v84, 0x40ddb3d7, v84
    ds_write_b32 v66, v84 offset:1024
    v_and_b32 v85, 0xffff0000, v62
    v_mul_f32 v85, 0x40ddb3d7, v85
    ds_write_b32 v66, v85 offset:3904
    v_lshlrev_b32 v86, 16, v63
    v_mul_f32 v86, 0x40ddb3d7, v86
    ds_write_b32 v66, v86 offset:6784
    v_and_b32 v87, 0xffff0000, v63
    v_mul_f32 v87, 0x40ddb3d7, v87
    ds_write_b32 v66, v87 offset:9664
    s_lshl_b32 s31, s4, 6
    v_add_u32 v80, s31, v0
    v_cmp_gt_u32 vcc, 208, v80
    s_and_saveexec_b64 s[40:41], vcc
    v_lshlrev_b32 v84, 16, v64
    v_mul_f32 v84, 0x40ddb3d7, v84
    ds_write_b32 v66, v84 offset:2048
    v_and_b32 v85, 0xffff0000, v64
    v_mul_f32 v85, 0x40ddb3d7, v85
    ds_write_b32 v66, v85 offset:4928
    v_lshlrev_b32 v86, 16, v65
    v_mul_f32 v86, 0x40ddb3d7, v86
    ds_write_b32 v66, v86 offset:7808
    v_and_b32 v87, 0xffff0000, v65
    v_mul_f32 v87, 0x40ddb3d7, v87
    ds_write_b32 v66, v87 offset:10688
    s_mov_b64 exec, s[40:41]
    s_mov_b32 s41, 25088
    s_setprio 3
    s_barrier
    ds_read_b128 v[92:95], v1 offset:0
    ds_read_b128 v[96:99], v2 offset:0
    ds_read_b128 v[100:103], v1 offset:64
    ds_read_b128 v[104:107], v2 offset:64
    ds_read_b64_tr_b16 v[112:113], v76 offset:0
    ds_read_b64_tr_b16 v[114:115], v76 offset:3072
    ds_read_b64_tr_b16 v[124:125], v76 offset:12288
    ds_read_b64_tr_b16 v[126:127], v76 offset:15360
    ds_read_b64_tr_b16 v[116:117], v77 offset:0
    ds_read_b64_tr_b16 v[118:119], v77 offset:3072
    ds_read_b64_tr_b16 v[128:129], v77 offset:12288
    ds_read_b64_tr_b16 v[130:131], v77 offset:15360
    ds_read_b64_tr_b16 v[120:121], v78 offset:0
    ds_read_b64_tr_b16 v[122:123], v78 offset:3072
    ds_read_b64_tr_b16 v[132:133], v78 offset:12288
    ds_read_b64_tr_b16 v[134:135], v78 offset:15360
    v_add_u32 v76, 25088, v76
    v_add_u32 v77, 25088, v77
    v_add_u32 v78, 25088, v78
    s_waitcnt lgkmcnt(10)
    v_mfma_f32_32x32x16_bf16 v[12:27], v[112:115], v[92:95], 0
    s_waitcnt lgkmcnt(8)
    v_mfma_f32_32x32x16_bf16 v[12:27], v[124:127], v[96:99], v[12:27]
    s_waitcnt lgkmcnt(6)
    v_mfma_f32_32x32x16_bf16 v[28:43], v[116:119], v[92:95], 0
    s_waitcnt lgkmcnt(4)
    v_mfma_f32_32x32x16_bf16 v[28:43], v[128:131], v[96:99], v[28:43]
    s_waitcnt lgkmcnt(2)
    v_mfma_f32_32x32x16_bf16 v[44:59], v[120:123], v[92:95], 0
    ds_read_b128 v[92:95], v1 offset:128
    s_waitcnt lgkmcnt(1)
    v_mfma_f32_32x32x16_bf16 v[44:59], v[132:135], v[96:99], v[44:59]
    ds_read_b128 v[96:99], v2 offset:128
    s_barrier
    ds_read_b64_tr_b16 v[136:137], v76 offset:0
    ds_read_b64_tr_b16 v[138:139], v76 offset:3072
    ds_read_b64_tr_b16 v[148:149], v76 offset:12288
    ds_read_b64_tr_b16 v[150:151], v76 offset:15360
    ds_read_b64_tr_b16 v[140:141], v77 offset:0
    ds_read_b64_tr_b16 v[142:143], v77 offset:3072
    ds_read_b64_tr_b16 v[152:153], v77 offset:12288
    ds_read_b64_tr_b16 v[154:155], v77 offset:15360
    ds_read_b64_tr_b16 v[144:145], v78 offset:0
    ds_read_b64_tr_b16 v[146:147], v78 offset:3072
    ds_read_b64_tr_b16 v[156:157], v78 offset:12288
    ds_read_b64_tr_b16 v[158:159], v78 offset:15360
    v_add_u32 v76, 36096, v76
    v_add_u32 v77, 36096, v77
    v_add_u32 v78, 36096, v78
    s_waitcnt lgkmcnt(10)
    v_mfma_f32_32x32x16_bf16 v[12:27], v[136:139], v[100:103], v[12:27]
    s_waitcnt lgkmcnt(8)
    v_mfma_f32_32x32x16_bf16 v[12:27], v[148:151], v[104:107], v[12:27]
    s_waitcnt lgkmcnt(6)
    v_mfma_f32_32x32x16_bf16 v[28:43], v[140:143], v[100:103], v[28:43]
    s_waitcnt lgkmcnt(4)
    v_mfma_f32_32x32x16_bf16 v[28:43], v[152:155], v[104:107], v[28:43]
    s_waitcnt lgkmcnt(2)
    v_mfma_f32_32x32x16_bf16 v[44:59], v[144:147], v[100:103], v[44:59]
    ds_read_b128 v[100:103], v1 offset:192
    s_waitcnt lgkmcnt(1)
    v_mfma_f32_32x32x16_bf16 v[44:59], v[156:159], v[104:107], v[44:59]
    ds_read_b128 v[104:107], v2 offset:192
    s_barrier
    ds_read_b64_tr_b16 v[160:161], v76 offset:0
    ds_read_b64_tr_b16 v[162:163], v76 offset:3072
    ds_read_b64_tr_b16 v[172:173], v76 offset:12288
    ds_read_b64_tr_b16 v[174:175], v76 offset:15360
    ds_read_b64_tr_b16 v[164:165], v77 offset:0
    ds_read_b64_tr_b16 v[166:167], v77 offset:3072
    ds_read_b64_tr_b16 v[176:177], v77 offset:12288
    ds_read_b64_tr_b16 v[178:179], v77 offset:15360
    ds_read_b64_tr_b16 v[168:169], v78 offset:0
    ds_read_b64_tr_b16 v[170:171], v78 offset:3072
    ds_read_b64_tr_b16 v[180:181], v78 offset:12288
    ds_read_b64_tr_b16 v[182:183], v78 offset:15360
    v_add_u32 v76, 24576, v76
    v_add_u32 v77, 24576, v77
    v_add_u32 v78, 24576, v78
    s_waitcnt lgkmcnt(10)
    v_mfma_f32_32x32x16_bf16 v[12:27], v[160:163], v[92:95], v[12:27]
    s_waitcnt lgkmcnt(8)
    v_mfma_f32_32x32x16_bf16 v[12:27], v[172:175], v[96:99], v[12:27]
    s_waitcnt lgkmcnt(6)
    v_mfma_f32_32x32x16_bf16 v[28:43], v[164:167], v[92:95], v[28:43]
    s_waitcnt lgkmcnt(4)
    v_mfma_f32_32x32x16_bf16 v[28:43], v[176:179], v[96:99], v[28:43]
    s_waitcnt lgkmcnt(2)
    v_mfma_f32_32x32x16_bf16 v[44:59], v[168:171], v[92:95], v[44:59]
    ds_read_b128 v[92:95], v1 offset:256
    s_waitcnt lgkmcnt(1)
    v_mfma_f32_32x32x16_bf16 v[44:59], v[180:183], v[96:99], v[44:59]
    ds_read_b128 v[96:99], v2 offset:256
    s_barrier
    ds_read_b64_tr_b16 v[184:185], v76 offset:0
    ds_read_b64_tr_b16 v[186:187], v76 offset:3072
    ds_read_b64_tr_b16 v[196:197], v76 offset:12288
    ds_read_b64_tr_b16 v[198:199], v76 offset:15360
    ds_read_b64_tr_b16 v[188:189], v77 offset:0
    ds_read_b64_tr_b16 v[190:191], v77 offset:3072
    ds_read_b64_tr_b16 v[200:201], v77 offset:12288
    ds_read_b64_tr_b16 v[202:203], v77 offset:15360
    ds_read_b64_tr_b16 v[192:193], v78 offset:0
    ds_read_b64_tr_b16 v[194:195], v78 offset:3072
    ds_read_b64_tr_b16 v[204:205], v78 offset:12288
    ds_read_b64_tr_b16 v[206:207], v78 offset:15360
    v_add_u32 v76, 4294881536, v76
    v_add_u32 v77, 4294881536, v77
    v_add_u32 v78, 4294881536, v78
    s_waitcnt lgkmcnt(10)
    v_mfma_f32_32x32x16_bf16 v[12:27], v[184:187], v[100:103], v[12:27]
    s_waitcnt lgkmcnt(8)
    v_mfma_f32_32x32x16_bf16 v[12:27], v[196:199], v[104:107], v[12:27]
    s_waitcnt lgkmcnt(6)
    v_mfma_f32_32x32x16_bf16 v[28:43], v[188:191], v[100:103], v[28:43]
    s_waitcnt lgkmcnt(4)
    v_mfma_f32_32x32x16_bf16 v[28:43], v[200:203], v[104:107], v[28:43]
    s_waitcnt lgkmcnt(2)
    v_mfma_f32_32x32x16_bf16 v[44:59], v[192:195], v[100:103], v[44:59]
    ds_read_b128 v[100:103], v1 offset:320
    s_waitcnt lgkmcnt(1)
    v_mfma_f32_32x32x16_bf16 v[44:59], v[204:207], v[104:107], v[44:59]
    ds_read_b128 v[104:107], v2 offset:320
    s_barrier
    ds_read_b64_tr_b16 v[208:209], v76 offset:0
    ds_read_b64_tr_b16 v[210:211], v76 offset:3072
    ds_read_b64_tr_b16 v[220:221], v76 offset:12288
    ds_read_b64_tr_b16 v[222:223], v76 offset:15360
    ds_read_b64_tr_b16 v[212:213], v77 offset:0
    ds_read_b64_tr_b16 v[214:215], v77 offset:3072
    ds_read_b64_tr_b16 v[224:225], v77 offset:12288
    ds_read_b64_tr_b16 v[226:227], v77 offset:15360
    ds_read_b64_tr_b16 v[216:217], v78 offset:0
    ds_read_b64_tr_b16 v[218:219], v78 offset:3072
    ds_read_b64_tr_b16 v[228:229], v78 offset:12288
    ds_read_b64_tr_b16 v[230:231], v78 offset:15360
    v_add_u32 v76, 25088, v76
    v_add_u32 v77, 25088, v77
    v_add_u32 v78, 25088, v78
    s_waitcnt lgkmcnt(10)
    v_mfma_f32_32x32x16_bf16 v[12:27], v[208:211], v[92:95], v[12:27]
    s_waitcnt lgkmcnt(8)
    v_mfma_f32_32x32x16_bf16 v[12:27], v[220:223], v[96:99], v[12:27]
    s_waitcnt lgkmcnt(6)
    v_mfma_f32_32x32x16_bf16 v[28:43], v[212:215], v[92:95], v[28:43]
    s_waitcnt lgkmcnt(4)
    v_mfma_f32_32x32x16_bf16 v[28:43], v[224:227], v[96:99], v[28:43]
    s_waitcnt lgkmcnt(2)
    v_mfma_f32_32x32x16_bf16 v[44:59], v[216:219], v[92:95], v[44:59]
    ds_read_b128 v[92:95], v1 offset:12544
    s_waitcnt lgkmcnt(1)
    v_mfma_f32_32x32x16_bf16 v[44:59], v[228:231], v[96:99], v[44:59]
    ds_read_b128 v[96:99], v2 offset:12544
    s_barrier
    ds_read_b64_tr_b16 v[232:233], v76 offset:0
    ds_read_b64_tr_b16 v[234:235], v76 offset:3072
    ds_read_b64_tr_b16 v[244:245], v76 offset:12288
    ds_read_b64_tr_b16 v[246:247], v76 offset:15360
    ds_read_b64_tr_b16 v[236:237], v77 offset:0
    ds_read_b64_tr_b16 v[238:239], v77 offset:3072
    ds_read_b64_tr_b16 v[248:249], v77 offset:12288
    ds_read_b64_tr_b16 v[250:251], v77 offset:15360
    ds_read_b64_tr_b16 v[240:241], v78 offset:0
    ds_read_b64_tr_b16 v[242:243], v78 offset:3072
    ds_read_b64_tr_b16 v[252:253], v78 offset:12288
    ds_read_b64_tr_b16 v[254:255], v78 offset:15360
    s_waitcnt lgkmcnt(10)
    v_mfma_f32_32x32x16_bf16 v[12:27], v[232:235], v[100:103], v[12:27]
    s_waitcnt lgkmcnt(8)
    v_mfma_f32_32x32x16_bf16 v[12:27], v[244:247], v[104:107], v[12:27]
    s_waitcnt lgkmcnt(6)
    v_mfma_f32_32x32x16_bf16 v[28:43], v[236:239], v[100:103], v[28:43]
    s_waitcnt lgkmcnt(4)
    v_mfma_f32_32x32x16_bf16 v[28:43], v[248:251], v[104:107], v[28:43]
    s_waitcnt lgkmcnt(2)
    v_mfma_f32_32x32x16_bf16 v[44:59], v[240:243], v[100:103], v[44:59]
    ds_read_b128 v[100:103], v1 offset:12608
    s_waitcnt lgkmcnt(1)
    v_mfma_f32_32x32x16_bf16 v[44:59], v[252:255], v[104:107], v[44:59]
    ds_read_b128 v[104:107], v2 offset:12608
    v_cvt_pk_bf16_f32 v20, v20, v21
    v_cvt_pk_bf16_f32 v21, v22, v23
    v_cvt_pk_bf16_f32 v22, v24, v25
    v_cvt_pk_bf16_f32 v23, v26, v27
    v_cvt_pk_bf16_f32 v84, v12, v13
    v_cvt_pk_bf16_f32 v85, v14, v15
    v_cvt_pk_bf16_f32 v86, v16, v17
    v_cvt_pk_bf16_f32 v87, v18, v19
    v_cvt_pk_bf16_f32 v76, v28, v29
    v_cvt_pk_bf16_f32 v77, v30, v31
    v_cvt_pk_bf16_f32 v78, v32, v33
    v_cvt_pk_bf16_f32 v79, v34, v35
    s_waitcnt lgkmcnt(0)
    s_nop 0
    s_branch L_A_JOIN
.p2align 3
L_A_LOOP:
    s_setprio 0
    v_fma_f32 v28, v28, s6, -v6
    v_fma_f32 v29, v29, s6, -v6
    v_fma_f32 v30, v30, s6, -v6
    v_fma_f32 v31, v31, s6, -v6
    v_fma_f32 v36, v36, s6, -v6
    v_fma_f32 v37, v37, s6, -v6
    v_fma_f32 v38, v38, s6, -v6
    v_fma_f32 v39, v39, s6, -v6
    v_exp_f32 v28, v28
    s_setprio 3
    s_waitcnt lgkmcnt(3)
    v_mfma_f32_32x32x16_bf16 v[12:27], v[112:115], v[92:95], 0
    s_setprio 0
    ds_read_b128 v[92:95], v1 offset:128
    v_exp_f32 v29, v29
    v_exp_f32 v30, v30
    v_exp_f32 v31, v31
    v_exp_f32 v36, v36
    s_setprio 3
    s_waitcnt lgkmcnt(3)
    v_mfma_f32_32x32x16_bf16 v[12:27], v[124:127], v[96:99], v[12:27]
    s_setprio 0
    ds_read_b128 v[96:99], v2 offset:128
    v_exp_f32 v37, v37
    v_exp_f32 v38, v38
    v_exp_f32 v39, v39
    v_cvt_pk_bf16_f32 v28, v28, v29
    v_cvt_pk_bf16_f32 v29, v30, v31
    s_setprio 3
    s_waitcnt lgkmcnt(3)
    v_mfma_f32_32x32x16_bf16 v[12:27], v[136:139], v[100:103], v[12:27]
    s_setprio 0
    ds_read_b128 v[100:103], v1 offset:192
    v_cvt_pk_bf16_f32 v30, v36, v37
    v_cvt_pk_bf16_f32 v31, v38, v39
    s_barrier
    ds_write_b128 v4, v[28:31] offset:0
    v_fma_f32 v32, v32, s6, -v6
    v_fma_f32 v33, v33, s6, -v6
    v_fma_f32 v34, v34, s6, -v6
    v_fma_f32 v35, v35, s6, -v6
    s_setprio 3
    s_waitcnt lgkmcnt(4)
    v_mfma_f32_32x32x16_bf16 v[12:27], v[148:151], v[104:107], v[12:27]
    s_setprio 0
    ds_read_b128 v[104:107], v2 offset:192
    v_fma_f32 v40, v40, s6, -v6
    v_fma_f32 v41, v41, s6, -v6
    v_fma_f32 v42, v42, s6, -v6
    v_fma_f32 v43, v43, s6, -v6
    v_exp_f32 v32, v32
    v_exp_f32 v33, v33
    v_exp_f32 v34, v34
    s_setprio 3
    s_waitcnt lgkmcnt(4)
    v_mfma_f32_32x32x16_bf16 v[12:27], v[160:163], v[92:95], v[12:27]
    s_setprio 0
    ds_read_b128 v[92:95], v1 offset:256
    v_exp_f32 v35, v35
    v_exp_f32 v40, v40
    v_exp_f32 v41, v41
    v_exp_f32 v42, v42
    s_setprio 3
    s_waitcnt lgkmcnt(4)
    v_mfma_f32_32x32x16_bf16 v[12:27], v[172:175], v[96:99], v[12:27]
    s_setprio 0
    ds_read_b128 v[96:99], v2 offset:256
    v_exp_f32 v43, v43
    v_cvt_pk_bf16_f32 v32, v32, v33
    v_cvt_pk_bf16_f32 v33, v34, v35
    v_cvt_pk_bf16_f32 v34, v40, v41
    v_cvt_pk_bf16_f32 v35, v42, v43
    ds_write_b128 v4, v[32:35] offset:2048
    s_setprio 3
    s_waitcnt lgkmcnt(5)
    v_mfma_f32_32x32x16_bf16 v[12:27], v[184:187], v[100:103], v[12:27]
    s_setprio 0
    ds_read_b128 v[100:103], v1 offset:320
    v_fma_f32 v44, v44, s6, -v6
    v_fma_f32 v45, v45, s6, -v6
    v_fma_f32 v46, v46, s6, -v6
    v_fma_f32 v47, v47, s6, -v6
    v_fma_f32 v52, v52, s6, -v6
    v_fma_f32 v53, v53, s6, -v6
    v_fma_f32 v54, v54, s6, -v6
    v_fma_f32 v55, v55, s6, -v6
    s_setprio 3
    s_waitcnt lgkmcnt(4)
    v_mfma_f32_32x32x16_bf16 v[12:27], v[196:199], v[104:107], v[12:27]
    s_setprio 0
    ds_read_b128 v[104:107], v2 offset:320
    v_exp_f32 v44, v44
    v_exp_f32 v45, v45
    v_exp_f32 v46, v46
    v_exp_f32 v47, v47
    s_setprio 3
    s_waitcnt lgkmcnt(4)
    v_mfma_f32_32x32x16_bf16 v[12:27], v[208:211], v[92:95], v[12:27]
    s_setprio 0
    ds_read_b128 v[92:95], v1 offset:0
    v_exp_f32 v52, v52
    v_exp_f32 v53, v53
    v_exp_f32 v54, v54
    s_setprio 3
    s_waitcnt lgkmcnt(4)
    v_mfma_f32_32x32x16_bf16 v[12:27], v[220:223], v[96:99], v[12:27]
    s_setprio 0
    ds_read_b128 v[96:99], v2 offset:0
    v_exp_f32 v55, v55
    v_cvt_pk_bf16_f32 v44, v44, v45
    v_cvt_pk_bf16_f32 v45, v46, v47
    v_cvt_pk_bf16_f32 v46, v52, v53
    v_cvt_pk_bf16_f32 v47, v54, v55
    ds_write_b128 v4, v[44:47] offset:4096
    s_setprio 3
    s_waitcnt lgkmcnt(4)
    v_mfma_f32_32x32x16_bf16 v[12:27], v[232:235], v[100:103], v[12:27]
    s_setprio 0
    ds_read_b128 v[100:103], v1 offset:64
    v_fma_f32 v48, v48, s6, -v6
    v_fma_f32 v49, v49, s6, -v6
    v_fma_f32 v50, v50, s6, -v6
    v_fma_f32 v51, v51, s6, -v6
    v_fma_f32 v56, v56, s6, -v6
    v_fma_f32 v57, v57, s6, -v6
    v_fma_f32 v58, v58, s6, -v6
    v_fma_f32 v59, v59, s6, -v6
    s_setprio 3
    s_waitcnt lgkmcnt(4)
    v_mfma_f32_32x32x16_bf16 v[12:27], v[244:247], v[104:107], v[12:27]
    s_setprio 0
    ds_read_b128 v[104:107], v2 offset:64
    v_exp_f32 v48, v48
    v_exp_f32 v49, v49
    v_exp_f32 v50, v50
    v_exp_f32 v51, v51
    s_setprio 3
    s_waitcnt lgkmcnt(4)
    v_mfma_f32_32x32x16_bf16 v[28:43], v[116:119], v[92:95], 0
    s_setprio 0
    v_exp_f32 v56, v56
    v_exp_f32 v57, v57
    v_exp_f32 v58, v58
    s_setprio 3
    s_waitcnt lgkmcnt(3)
    v_mfma_f32_32x32x16_bf16 v[28:43], v[128:131], v[96:99], v[28:43]
    s_setprio 0
    v_exp_f32 v59, v59
    v_cvt_pk_bf16_f32 v48, v48, v49
    v_cvt_pk_bf16_f32 v49, v50, v51
    v_cvt_pk_bf16_f32 v50, v56, v57
    v_cvt_pk_bf16_f32 v51, v58, v59
    ds_write_b128 v4, v[48:51] offset:6144
    s_setprio 3
    v_mfma_f32_32x32x16_bf16 v[44:59], v[120:123], v[92:95], 0
    s_setprio 0
    ds_read_b128 v[92:95], v1 offset:128
    s_cbranch_vccnz L_MASKB
L_MRETB:
    v_max3_f32 v5, v60, v61, v62
    v_max3_f32 v7, v76, v77, v78
    v_max3_f32 v5, v5, v63, v64
    v_max3_f32 v7, v7, v79, v80
    v_max3_f32 v5, v5, v65, v66
    v_max3_f32 v7, v7, v81, v82
    s_setprio 3
    v_mfma_f32_32x32x16_bf16 v[44:59], v[132:135], v[96:99], v[44:59]
    s_setprio 0
    ds_read_b128 v[96:99], v2 offset:128
    v_max3_f32 v5, v5, v67, v68
    v_max3_f32 v7, v7, v83, v84
    v_max3_f32 v5, v5, v69, v70
    v_max3_f32 v7, v7, v85, v86
    v_max3_f32 v5, v5, v71, v72
    v_max3_f32 v7, v7, v87, v88
    s_setprio 3
    s_waitcnt lgkmcnt(4)
    v_mfma_f32_32x32x16_bf16 v[28:43], v[140:143], v[100:103], v[28:43]
    s_setprio 0
    v_max3_f32 v5, v5, v73, v74
    v_max3_f32 v7, v7, v89, v90
    v_max_f32 v7, v7, v91
    v_max3_f32 v5, v5, v7, v75
    v_mov_b32 v7, v5
    s_nop 1
    v_permlane32_swap_b32 v5, v7
    s_setprio 3
    s_waitcnt lgkmcnt(3)
    v_mfma_f32_32x32x16_bf16 v[28:43], v[152:155], v[104:107], v[28:43]
    s_setprio 0
    v_max_f32 v5, v5, v7
    v_mul_f32 v6, s6, v5
    v_fma_f32 v76, v76, s6, -v6
    v_fma_f32 v77, v77, s6, -v6
    v_fma_f32 v78, v78, s6, -v6
    v_fma_f32 v79, v79, s6, -v6
    s_setprio 3
    v_mfma_f32_32x32x16_bf16 v[44:59], v[144:147], v[100:103], v[44:59]
    s_setprio 0
    ds_read_b128 v[100:103], v1 offset:192
    v_fma_f32 v84, v84, s6, -v6
    v_fma_f32 v85, v85, s6, -v6
    v_fma_f32 v86, v86, s6, -v6
    v_fma_f32 v87, v87, s6, -v6
    v_exp_f32 v76, v76
    s_setprio 3
    v_mfma_f32_32x32x16_bf16 v[44:59], v[156:159], v[104:107], v[44:59]
    s_setprio 0
    ds_read_b128 v[104:107], v2 offset:192
    v_exp_f32 v77, v77
    v_exp_f32 v78, v78
    v_exp_f32 v79, v79
    s_setprio 3
    s_waitcnt lgkmcnt(3)
    v_mfma_f32_32x32x16_bf16 v[28:43], v[164:167], v[92:95], v[28:43]
    s_setprio 0
    v_exp_f32 v84, v84
    v_exp_f32 v85, v85
    v_exp_f32 v86, v86
    s_setprio 3
    s_waitcnt lgkmcnt(2)
    v_mfma_f32_32x32x16_bf16 v[28:43], v[176:179], v[96:99], v[28:43]
    s_setprio 0
    v_exp_f32 v87, v87
    v_cvt_pk_bf16_f32 v76, v76, v77
    v_cvt_pk_bf16_f32 v77, v78, v79
    v_cvt_pk_bf16_f32 v78, v84, v85
    v_cvt_pk_bf16_f32 v79, v86, v87
    s_setprio 3
    v_mfma_f32_32x32x16_bf16 v[44:59], v[168:171], v[92:95], v[44:59]
    s_setprio 0
    ds_read_b128 v[92:95], v1 offset:256
    ds_write_b128 v4, v[76:79] offset:4608
    v_fma_f32 v80, v80, s6, -v6
    v_fma_f32 v81, v81, s6, -v6
    v_fma_f32 v82, v82, s6, -v6
    v_fma_f32 v83, v83, s6, -v6
    v_fma_f32 v88, v88, s6, -v6
    s_setprio 3
    v_mfma_f32_32x32x16_bf16 v[44:59], v[180:183], v[96:99], v[44:59]
    s_setprio 0
    ds_read_b128 v[96:99], v2 offset:256
    v_fma_f32 v89, v89, s6, -v6
    v_fma_f32 v90, v90, s6, -v6
    v_fma_f32 v91, v91, s6, -v6
    v_exp_f32 v80, v80
    v_exp_f32 v81, v81
    s_setprio 3
    s_waitcnt lgkmcnt(4)
    v_mfma_f32_32x32x16_bf16 v[28:43], v[188:191], v[100:103], v[28:43]
    s_setprio 0
    v_exp_f32 v82, v82
    v_exp_f32 v83, v83
    v_exp_f32 v88, v88
    s_setprio 3
    s_waitcnt lgkmcnt(3)
    v_mfma_f32_32x32x16_bf16 v[28:43], v[200:203], v[104:107], v[28:43]
    s_setprio 0
    v_exp_f32 v89, v89
    v_exp_f32 v90, v90
    v_exp_f32 v91, v91
    s_setprio 3
    v_mfma_f32_32x32x16_bf16 v[44:59], v[192:195], v[100:103], v[44:59]
    s_setprio 0
    ds_read_b128 v[100:103], v1 offset:320
    v_cvt_pk_bf16_f32 v80, v80, v81
    v_cvt_pk_bf16_f32 v81, v82, v83
    v_cvt_pk_bf16_f32 v82, v88, v89
    v_cvt_pk_bf16_f32 v83, v90, v91
    ds_write_b128 v4, v[80:83] offset:6656
    s_setprio 3
    v_mfma_f32_32x32x16_bf16 v[44:59], v[204:207], v[104:107], v[44:59]
    s_setprio 0
    ds_read_b128 v[104:107], v2 offset:320
    v_fma_f32 v60, v60, s6, -v6
    v_fma_f32 v61, v61, s6, -v6
    v_fma_f32 v62, v62, s6, -v6
    v_fma_f32 v63, v63, s6, -v6
    v_fma_f32 v68, v68, s6, -v6
    v_fma_f32 v69, v69, s6, -v6
    v_fma_f32 v70, v70, s6, -v6
    s_setprio 3
    s_waitcnt lgkmcnt(5)
    v_mfma_f32_32x32x16_bf16 v[28:43], v[212:215], v[92:95], v[28:43]
    s_setprio 0
    v_fma_f32 v71, v71, s6, -v6
    v_exp_f32 v60, v60
    v_exp_f32 v61, v61
    v_exp_f32 v62, v62
    s_setprio 3
    s_waitcnt lgkmcnt(3)
    v_mfma_f32_32x32x16_bf16 v[28:43], v[224:227], v[96:99], v[28:43]
    s_setprio 0
    v_exp_f32 v63, v63
    v_exp_f32 v68, v68
    v_exp_f32 v69, v69
    s_setprio 3
    v_mfma_f32_32x32x16_bf16 v[44:59], v[216:219], v[92:95], v[44:59]
    s_setprio 0
    ds_read_b128 v[92:95], v1 offset:12544
    v_exp_f32 v70, v70
    v_exp_f32 v71, v71
    v_cvt_pk_bf16_f32 v60, v60, v61
    v_cvt_pk_bf16_f32 v61, v62, v63
    s_setprio 3
    v_mfma_f32_32x32x16_bf16 v[44:59], v[228:231], v[96:99], v[44:59]
    s_setprio 0
    ds_read_b128 v[96:99], v2 offset:12544
    v_cvt_pk_bf16_f32 v62, v68, v69
    v_cvt_pk_bf16_f32 v63, v70, v71
    ds_write_b128 v4, v[60:63] offset:512
    v_fma_f32 v64, v64, s6, -v6
    v_fma_f32 v65, v65, s6, -v6
    v_fma_f32 v66, v66, s6, -v6
    v_fma_f32 v67, v67, s6, -v6
    s_setprio 3
    s_waitcnt lgkmcnt(5)
    v_mfma_f32_32x32x16_bf16 v[28:43], v[236:239], v[100:103], v[28:43]
    s_setprio 0
    v_fma_f32 v72, v72, s6, -v6
    v_fma_f32 v73, v73, s6, -v6
    v_fma_f32 v74, v74, s6, -v6
    v_fma_f32 v75, v75, s6, -v6
    v_exp_f32 v64, v64
    s_setprio 3
    s_waitcnt lgkmcnt(3)
    v_mfma_f32_32x32x16_bf16 v[28:43], v[248:251], v[104:107], v[28:43]
    s_setprio 0
    v_exp_f32 v65, v65
    v_exp_f32 v66, v66
    v_exp_f32 v67, v67
    v_exp_f32 v72, v72
    v_cvt_pk_bf16_f32 v20, v20, v21
    v_cvt_pk_bf16_f32 v21, v22, v23
    v_cvt_pk_bf16_f32 v22, v24, v25
    v_cvt_pk_bf16_f32 v23, v26, v27
    s_setprio 3
    v_mfma_f32_32x32x16_bf16 v[44:59], v[240:243], v[100:103], v[44:59]
    s_setprio 0
    ds_read_b128 v[100:103], v1 offset:12608
    v_exp_f32 v73, v73
    v_exp_f32 v74, v74
    v_exp_f32 v75, v75
    v_cvt_pk_bf16_f32 v84, v12, v13
    v_cvt_pk_bf16_f32 v85, v14, v15
    v_cvt_pk_bf16_f32 v86, v16, v17
    v_cvt_pk_bf16_f32 v87, v18, v19
    s_setprio 3
    v_mfma_f32_32x32x16_bf16 v[44:59], v[252:255], v[104:107], v[44:59]
    s_setprio 0
    ds_read_b128 v[104:107], v2 offset:12608
    v_cvt_pk_bf16_f32 v64, v64, v65
    v_cvt_pk_bf16_f32 v65, v66, v67
    v_cvt_pk_bf16_f32 v66, v72, v73
    v_cvt_pk_bf16_f32 v67, v74, v75
    ds_write_b128 v4, v[64:67] offset:2560
    v_cvt_pk_bf16_f32 v76, v28, v29
    v_cvt_pk_bf16_f32 v77, v30, v31
    v_cvt_pk_bf16_f32 v78, v32, v33
    v_cvt_pk_bf16_f32 v79, v34, v35
L_A_JOIN:
    s_setprio 3
    s_waitcnt lgkmcnt(5)
    v_mfma_f32_32x32x16_bf16 v[60:75], v[120:123], v[92:95], 0
    s_setprio 1
    v_cvt_pk_bf16_f32 v24, v36, v37
    v_cvt_pk_bf16_f32 v25, v38, v39
    v_cvt_pk_bf16_f32 v26, v40, v41
    v_cvt_pk_bf16_f32 v27, v42, v43
    s_waitcnt lgkmcnt(4)
    v_mfma_f32_32x32x16_bf16 v[60:75], v[132:135], v[96:99], v[60:75]
    v_cvt_pk_bf16_f32 v80, v44, v45
    v_cvt_pk_bf16_f32 v81, v46, v47
    v_cvt_pk_bf16_f32 v82, v48, v49
    v_cvt_pk_bf16_f32 v83, v50, v51
    s_waitcnt lgkmcnt(0)
    s_barrier
    v_mfma_f32_32x32x16_bf16 v[28:43], v[112:115], v[92:95], 0
    v_cvt_pk_bf16_f32 v12, v52, v53
    v_cvt_pk_bf16_f32 v13, v54, v55
    v_cvt_pk_bf16_f32 v14, v56, v57
    v_cvt_pk_bf16_f32 v15, v58, v59
    v_mfma_f32_32x32x16_bf16 v[28:43], v[124:127], v[96:99], v[28:43]
    v_mfma_f32_32x32x16_bf16 v[44:59], v[116:119], v[92:95], 0
    ds_read_b128 v[92:95], v1 offset:12672
    v_mfma_f32_32x32x16_bf16 v[44:59], v[128:131], v[96:99], v[44:59]
    ds_read_b128 v[96:99], v2 offset:12672
    v_mfma_f32_32x32x16_bf16 v[28:43], v[136:139], v[100:103], v[28:43]
    s_add_i32 s30, s5, 0
    s_lshl_b32 s30, s30, 8
    v_mfma_f32_32x32x16_bf16 v[28:43], v[148:151], v[104:107], v[28:43]
    s_add_u32 s30, s30, s2
    s_mul_i32 s28, s30, 43691
    v_mfma_f32_32x32x16_bf16 v[44:59], v[140:143], v[100:103], v[44:59]
    s_lshr_b32 s28, s28, 21
    v_mfma_f32_32x32x16_bf16 v[44:59], v[152:155], v[104:107], v[44:59]
    s_mul_i32 s29, s28, 48
    s_sub_u32 s29, s30, s29
    v_mfma_f32_32x32x16_bf16 v[60:75], v[144:147], v[100:103], v[60:75]
    ds_read_b128 v[100:103], v1 offset:12736
    s_cmp_eq_u32 s28, 47
    v_mfma_f32_32x32x16_bf16 v[60:75], v[156:159], v[104:107], v[60:75]
    ds_read_b128 v[104:107], v2 offset:12736
    s_cselect_b32 s34, 1, 0
    s_cmp_eq_u32 s29, 47
    s_waitcnt lgkmcnt(3)
    v_mfma_f32_32x32x16_bf16 v[28:43], v[160:163], v[92:95], v[28:43]
    s_cselect_b32 s35, 1, 0
    s_waitcnt lgkmcnt(2)
    v_mfma_f32_32x32x16_bf16 v[28:43], v[172:175], v[96:99], v[28:43]
    s_or_b32 s30, s34, s35
    s_cselect_b64 vcc, -1, 0
    v_mfma_f32_32x32x16_bf16 v[44:59], v[164:167], v[92:95], v[44:59]
    s_add_u32 s7, s7, 25088
    v_mfma_f32_32x32x16_bf16 v[44:59], v[176:179], v[96:99], v[44:59]
    s_cmp_eq_u32 s7, 75264
    s_cselect_b32 s32, -50176, s41
    v_mfma_f32_32x32x16_bf16 v[60:75], v[168:171], v[92:95], v[60:75]
    ds_read_b128 v[92:95], v1 offset:12800
    s_cselect_b32 s7, 0, s7
    v_mfma_f32_32x32x16_bf16 v[60:75], v[180:183], v[96:99], v[60:75]
    ds_read_b128 v[96:99], v2 offset:12800
    s_waitcnt lgkmcnt(3)
    v_mfma_f32_32x32x16_bf16 v[28:43], v[184:187], v[100:103], v[28:43]
    s_cmp_eq_u32 s5, 0
    s_cbranch_scc1 L_A_B7
L_A_B7R:
    s_waitcnt lgkmcnt(2)
    v_mfma_f32_32x32x16_bf16 v[28:43], v[196:199], v[104:107], v[28:43]
    v_mfma_f32_32x32x16_bf16 v[44:59], v[188:191], v[100:103], v[44:59]
    v_mfma_f32_32x32x16_bf16 v[44:59], v[200:203], v[104:107], v[44:59]
    v_mfma_f32_32x32x16_bf16 v[60:75], v[192:195], v[100:103], v[60:75]
    ds_read_b128 v[100:103], v1 offset:12864
    v_mfma_f32_32x32x16_bf16 v[60:75], v[204:207], v[104:107], v[60:75]
    ds_read_b128 v[104:107], v2 offset:12864
    s_waitcnt lgkmcnt(3)
    v_mfma_f32_32x32x16_bf16 v[28:43], v[208:211], v[92:95], v[28:43]
    s_waitcnt lgkmcnt(2)
    v_mfma_f32_32x32x16_bf16 v[28:43], v[220:223], v[96:99], v[28:43]
    v_mfma_f32_32x32x16_bf16 v[44:59], v[212:215], v[92:95], v[44:59]
    v_mfma_f32_32x32x16_bf16 v[44:59], v[224:227], v[96:99], v[44:59]
    v_add_u32 v1, s32, v1
    v_add_u32 v2, s32, v2
    s_waitcnt lgkmcnt(1)
    v_mfma_f32_32x32x16_bf16 v[28:43], v[232:235], v[100:103], v[28:43]
    s_waitcnt lgkmcnt(0)
    v_mfma_f32_32x32x16_bf16 v[28:43], v[244:247], v[104:107], v[28:43]
    v_mfma_f32_32x32x16_bf16 v[60:75], v[216:219], v[92:95], v[60:75]
    v_mfma_f32_32x32x16_bf16 v[60:75], v[228:231], v[96:99], v[60:75]
    v_cvt_pk_bf16_f32 v108, v28, v29
    v_cvt_pk_bf16_f32 v109, v30, v31
    v_cvt_pk_bf16_f32 v110, v32, v33
    v_cvt_pk_bf16_f32 v111, v34, v35
    v_mfma_f32_32x32x16_bf16 v[44:59], v[236:239], v[100:103], v[44:59]
    v_cvt_pk_bf16_f32 v92, v36, v37
    v_cvt_pk_bf16_f32 v93, v38, v39
    v_cvt_pk_bf16_f32 v94, v40, v41
    v_cvt_pk_bf16_f32 v95, v42, v43
    ds_read_b128 v[28:31], v3 offset:1216
    ds_read_b128 v[32:35], v3 offset:832
    ds_read_b128 v[36:39], v3 offset:448
    ds_read_b128 v[40:43], v3 offset:64
    v_mfma_f32_32x32x16_bf16 v[44:59], v[248:251], v[104:107], v[44:59]
    v_mfma_f32_32x32x16_bf16 v[60:75], v[240:243], v[100:103], v[60:75]
    v_mfma_f32_32x32x16_bf16 v[60:75], v[252:255], v[104:107], v[60:75]
    v_cvt_pk_bf16_f32 v100, v52, v53
    v_cvt_pk_bf16_f32 v101, v54, v55
    v_cvt_pk_bf16_f32 v102, v56, v57
    v_cvt_pk_bf16_f32 v103, v58, v59
    v_cvt_pk_bf16_f32 v96, v44, v45
    v_cvt_pk_bf16_f32 v97, v46, v47
    v_cvt_pk_bf16_f32 v98, v48, v49
    v_cvt_pk_bf16_f32 v99, v50, v51
    ds_read_b128 v[44:47], v3 offset:1280
    ds_read_b128 v[48:51], v3 offset:896
    ds_read_b128 v[52:55], v3 offset:512
    ds_read_b128 v[56:59], v3 offset:128
    s_waitcnt lgkmcnt(4)
    v_mfma_f32_32x32x16_bf16 v[28:43], v[20:23], v[84:87], v[28:43]
    v_mfma_f32_32x32x16_bf16 v[28:43], v[24:27], v[76:79], v[28:43]
    v_cvt_pk_bf16_f32 v104, v68, v69
    v_cvt_pk_bf16_f32 v105, v70, v71
    v_cvt_pk_bf16_f32 v106, v72, v73
    v_cvt_pk_bf16_f32 v107, v74, v75
    v_mfma_f32_32x32x16_bf16 v[28:43], v[12:15], v[80:83], v[28:43]
    v_cvt_pk_bf16_f32 v16, v60, v61
    v_cvt_pk_bf16_f32 v17, v62, v63
    v_cvt_pk_bf16_f32 v18, v64, v65
    v_cvt_pk_bf16_f32 v19, v66, v67
    ds_read_b128 v[60:63], v3 offset:1152
    ds_read_b128 v[64:67], v3 offset:768
    ds_read_b128 v[68:71], v3 offset:384
    ds_read_b128 v[72:75], v3 offset:0
    s_waitcnt lgkmcnt(4)
    v_mfma_f32_32x32x16_bf16 v[44:59], v[92:95], v[84:87], v[44:59]
    v_mfma_f32_32x32x16_bf16 v[44:59], v[100:103], v[76:79], v[44:59]
    v_mfma_f32_32x32x16_bf16 v[44:59], v[104:107], v[80:83], v[44:59]
    s_cmp_le_u32 s5, 1
    s_cbranch_scc1 L_A_B8
L_A_B8R:
    ds_read_b128 v[76:79], v3 offset:1216
    ds_read_b128 v[80:83], v3 offset:832
    ds_read_b128 v[84:87], v3 offset:448
    ds_read_b128 v[88:91], v3 offset:64
    s_waitcnt lgkmcnt(4)
    v_mfma_f32_32x32x16_bf16 v[60:75], v[20:23], v[108:111], v[60:75]
    s_add_u32 s5, s5, 1
    s_cmp_lt_u32 s5, 9
    v_mfma_f32_32x32x16_bf16 v[60:75], v[24:27], v[96:99], v[60:75]
    s_cbranch_vccnz L_MASKA
L_MRETA:
    v_max3_f32 v5, v28, v29, v30
    v_max3_f32 v7, v44, v45, v46
    v_max3_f32 v5, v5, v31, v32
    v_max3_f32 v7, v7, v47, v48
    v_mfma_f32_32x32x16_bf16 v[60:75], v[12:15], v[16:19], v[60:75]
    v_max3_f32 v5, v5, v33, v34
    v_max3_f32 v7, v7, v49, v50
    v_max3_f32 v5, v5, v35, v36
    v_max3_f32 v7, v7, v51, v52
    s_waitcnt lgkmcnt(0)
    v_mfma_f32_32x32x16_bf16 v[76:91], v[92:95], v[108:111], v[76:91]
    ds_read_b128 v[92:95], v1 offset:0
    v_max3_f32 v5, v5, v37, v38
    v_max3_f32 v7, v7, v53, v54
    v_max3_f32 v5, v5, v39, v40
    v_max3_f32 v7, v7, v55, v56
    v_mfma_f32_32x32x16_bf16 v[76:91], v[100:103], v[96:99], v[76:91]
    ds_read_b128 v[96:99], v2 offset:0
    ds_read_b128 v[100:103], v1 offset:64
    v_max3_f32 v5, v5, v41, v42
    v_max3_f32 v7, v7, v57, v58
    v_max_f32 v7, v7, v59
    v_max3_f32 v5, v5, v7, v43
    v_mfma_f32_32x32x16_bf16 v[76:91], v[104:107], v[16:19], v[76:91]
    ds_read_b128 v[104:107], v2 offset:64
    v_mov_b32 v7, v5
    s_nop 1
    v_permlane32_swap_b32 v5, v7
    v_max_f32 v5, v5, v7
    v_mul_f32 v6, s6, v5
    s_cbranch_scc1 L_A_LOOP
    s_setprio 3
    v_fma_f32 v28, v28, s6, -v6
    v_fma_f32 v29, v29, s6, -v6
    v_fma_f32 v30, v30, s6, -v6
    v_fma_f32 v31, v31, s6, -v6
    v_fma_f32 v36, v36, s6, -v6
    v_fma_f32 v37, v37, s6, -v6
    v_fma_f32 v38, v38, s6, -v6
    v_fma_f32 v39, v39, s6, -v6
    v_exp_f32 v28, v28
    v_exp_f32 v29, v29
    v_exp_f32 v30, v30
    v_exp_f32 v31, v31
    v_exp_f32 v36, v36
    v_exp_f32 v37, v37
    v_exp_f32 v38, v38
    v_exp_f32 v39, v39
    v_cvt_pk_bf16_f32 v28, v28, v29
    v_cvt_pk_bf16_f32 v29, v30, v31
    v_cvt_pk_bf16_f32 v30, v36, v37
    v_cvt_pk_bf16_f32 v31, v38, v39
    s_barrier
    ds_write_b128 v4, v[28:31] offset:0
    v_fma_f32 v32, v32, s6, -v6
    v_fma_f32 v33, v33, s6, -v6
    v_fma_f32 v34, v34, s6, -v6
    v_fma_f32 v35, v35, s6, -v6
    v_fma_f32 v40, v40, s6, -v6
    v_fma_f32 v41, v41, s6, -v6
    v_fma_f32 v42, v42, s6, -v6
    v_fma_f32 v43, v43, s6, -v6
    v_exp_f32 v32, v32
    v_exp_f32 v33, v33
    v_exp_f32 v34, v34
    v_exp_f32 v35, v35
    v_exp_f32 v40, v40
    v_exp_f32 v41, v41
    v_exp_f32 v42, v42
    v_exp_f32 v43, v43
    v_cvt_pk_bf16_f32 v32, v32, v33
    v_cvt_pk_bf16_f32 v33, v34, v35
    v_cvt_pk_bf16_f32 v34, v40, v41
    v_cvt_pk_bf16_f32 v35, v42, v43
    ds_write_b128 v4, v[32:35] offset:2048
    v_fma_f32 v44, v44, s6, -v6
    v_fma_f32 v45, v45, s6, -v6
    v_fma_f32 v46, v46, s6, -v6
    v_fma_f32 v47, v47, s6, -v6
    v_fma_f32 v52, v52, s6, -v6
    v_fma_f32 v53, v53, s6, -v6
    v_fma_f32 v54, v54, s6, -v6
    v_fma_f32 v55, v55, s6, -v6
    v_exp_f32 v44, v44
    v_exp_f32 v45, v45
    v_exp_f32 v46, v46
    v_exp_f32 v47, v47
    v_exp_f32 v52, v52
    v_exp_f32 v53, v53
    v_exp_f32 v54, v54
    v_exp_f32 v55, v55
    v_cvt_pk_bf16_f32 v44, v44, v45
    v_cvt_pk_bf16_f32 v45, v46, v47
    v_cvt_pk_bf16_f32 v46, v52, v53
    v_cvt_pk_bf16_f32 v47, v54, v55
    ds_write_b128 v4, v[44:47] offset:4096
    v_fma_f32 v48, v48, s6, -v6
    v_fma_f32 v49, v49, s6, -v6
    v_fma_f32 v50, v50, s6, -v6
    v_fma_f32 v51, v51, s6, -v6
    v_fma_f32 v56, v56, s6, -v6
    v_fma_f32 v57, v57, s6, -v6
    v_fma_f32 v58, v58, s6, -v6
    v_fma_f32 v59, v59, s6, -v6
    v_exp_f32 v48, v48
    v_exp_f32 v49, v49
    v_exp_f32 v50, v50
    v_exp_f32 v51, v51
    v_exp_f32 v56, v56
    v_exp_f32 v57, v57
    v_exp_f32 v58, v58
    v_exp_f32 v59, v59
    v_cvt_pk_bf16_f32 v48, v48, v49
    v_cvt_pk_bf16_f32 v49, v50, v51
    v_cvt_pk_bf16_f32 v50, v56, v57
    v_cvt_pk_bf16_f32 v51, v58, v59
    ds_write_b128 v4, v[48:51] offset:6144
    s_cbranch_vccnz L_MASKC
L_MRETC:
    v_max3_f32 v5, v60, v61, v62
    v_max3_f32 v7, v76, v77, v78
    v_max3_f32 v5, v5, v63, v64
    v_max3_f32 v7, v7, v79, v80
    v_max3_f32 v5, v5, v65, v66
    v_max3_f32 v7, v7, v81, v82
    v_max3_f32 v5, v5, v67, v68
    v_max3_f32 v7, v7, v83, v84
    v_max3_f32 v5, v5, v69, v70
    v_max3_f32 v7, v7, v85, v86
    v_max3_f32 v5, v5, v71, v72
    v_max3_f32 v7, v7, v87, v88
    v_max3_f32 v5, v5, v73, v74
    v_max3_f32 v7, v7, v89, v90
    v_max_f32 v7, v7, v91
    v_max3_f32 v5, v5, v7, v75
    v_mov_b32 v7, v5
    s_nop 1
    v_permlane32_swap_b32 v5, v7
    v_max_f32 v5, v5, v7
    v_mul_f32 v6, s6, v5
    v_fma_f32 v76, v76, s6, -v6
    v_fma_f32 v77, v77, s6, -v6
    v_fma_f32 v78, v78, s6, -v6
    v_fma_f32 v79, v79, s6, -v6
    v_fma_f32 v84, v84, s6, -v6
    v_fma_f32 v85, v85, s6, -v6
    v_fma_f32 v86, v86, s6, -v6
    v_fma_f32 v87, v87, s6, -v6
    v_exp_f32 v76, v76
    v_exp_f32 v77, v77
    v_exp_f32 v78, v78
    v_exp_f32 v79, v79
    v_exp_f32 v84, v84
    v_exp_f32 v85, v85
    v_exp_f32 v86, v86
    v_exp_f32 v87, v87
    v_cvt_pk_bf16_f32 v76, v76, v77
    v_cvt_pk_bf16_f32 v77, v78, v79
    v_cvt_pk_bf16_f32 v78, v84, v85
    v_cvt_pk_bf16_f32 v79, v86, v87
    ds_write_b128 v4, v[76:79] offset:4608
    v_fma_f32 v80, v80, s6, -v6
    v_fma_f32 v81, v81, s6, -v6
    v_fma_f32 v82, v82, s6, -v6
    v_fma_f32 v83, v83, s6, -v6
    v_fma_f32 v88, v88, s6, -v6
    v_fma_f32 v89, v89, s6, -v6
    v_fma_f32 v90, v90, s6, -v6
    v_fma_f32 v91, v91, s6, -v6
    v_exp_f32 v80, v80
    v_exp_f32 v81, v81
    v_exp_f32 v82, v82
    v_exp_f32 v83, v83
    v_exp_f32 v88, v88
    v_exp_f32 v89, v89
    v_exp_f32 v90, v90
    v_exp_f32 v91, v91
    v_cvt_pk_bf16_f32 v80, v80, v81
    v_cvt_pk_bf16_f32 v81, v82, v83
    v_cvt_pk_bf16_f32 v82, v88, v89
    v_cvt_pk_bf16_f32 v83, v90, v91
    ds_write_b128 v4, v[80:83] offset:6656
    v_fma_f32 v60, v60, s6, -v6
    v_fma_f32 v61, v61, s6, -v6
    v_fma_f32 v62, v62, s6, -v6
    v_fma_f32 v63, v63, s6, -v6
    v_fma_f32 v68, v68, s6, -v6
    v_fma_f32 v69, v69, s6, -v6
    v_fma_f32 v70, v70, s6, -v6
    v_fma_f32 v71, v71, s6, -v6
    v_exp_f32 v60, v60
    v_exp_f32 v61, v61
    v_exp_f32 v62, v62
    v_exp_f32 v63, v63
    v_exp_f32 v68, v68
    v_exp_f32 v69, v69
    v_exp_f32 v70, v70
    v_exp_f32 v71, v71
    v_cvt_pk_bf16_f32 v60, v60, v61
    v_cvt_pk_bf16_f32 v61, v62, v63
    v_cvt_pk_bf16_f32 v62, v68, v69
    v_cvt_pk_bf16_f32 v63, v70, v71
    ds_write_b128 v4, v[60:63] offset:512
    v_fma_f32 v64, v64, s6, -v6
    v_fma_f32 v65, v65, s6, -v6
    v_fma_f32 v66, v66, s6, -v6
    v_fma_f32 v67, v67, s6, -v6
    v_fma_f32 v72, v72, s6, -v6
    v_fma_f32 v73, v73, s6, -v6
    v_fma_f32 v74, v74, s6, -v6
    v_fma_f32 v75, v75, s6, -v6
    v_exp_f32 v64, v64
    v_exp_f32 v65, v65
    v_exp_f32 v66, v66
    v_exp_f32 v67, v67
    v_exp_f32 v72, v72
    v_exp_f32 v73, v73
    v_exp_f32 v74, v74
    v_exp_f32 v75, v75
    v_cvt_pk_bf16_f32 v64, v64, v65
    v_cvt_pk_bf16_f32 v65, v66, v67
    v_cvt_pk_bf16_f32 v66, v72, v73
    v_cvt_pk_bf16_f32 v67, v74, v75
    ds_write_b128 v4, v[64:67] offset:2560
    s_waitcnt lgkmcnt(0)
    s_barrier
    s_barrier
    s_endpgm
L_A_B7:
    s_barrier
    s_branch L_A_B7R
L_A_B8:
    s_barrier
    s_branch L_A_B8R
L_MASKA:
    s_nop 12
    v_bfe_u32 v8, v0, 4, 1
    v_and_b32 v8, s34, v8
    v_xor_b32 v9, s34, v8
    v_or_b32 v10, s35, v8
    v_or_b32 v11, s35, v9
    v_cvt_f32_u32 v8, v8
    v_mul_f32 v8, 0xc42d3480, v8
    v_cvt_f32_u32 v9, v9
    v_mul_f32 v9, 0xc42d3480, v9
    v_cvt_f32_u32 v10, v10
    v_mul_f32 v10, 0xc42d3480, v10
    v_cvt_f32_u32 v11, v11
    v_mul_f32 v11, 0xc42d3480, v11
    v_add_f32 v28, v28, v8
    v_add_f32 v29, v29, v8
    v_add_f32 v30, v30, v8
    v_add_f32 v31, v31, v8
    v_add_f32 v32, v32, v8
    v_add_f32 v33, v33, v8
    v_add_f32 v34, v34, v8
    v_add_f32 v35, v35, v8
    v_add_f32 v36, v36, v9
    v_add_f32 v37, v37, v9
    v_add_f32 v38, v38, v9
    v_add_f32 v39, v39, v9
    v_add_f32 v40, v40, v9
    v_add_f32 v41, v41, v9
    v_add_f32 v42, v42, v9
    v_add_f32 v43, v43, v9
    v_add_f32 v44, v44, v10
    v_add_f32 v45, v45, v10
    v_add_f32 v46, v46, v10
    v_add_f32 v47, v47, v10
    v_add_f32 v48, v48, v10
    v_add_f32 v49, v49, v10
    v_add_f32 v50, v50, v10
    v_add_f32 v51, v51, v10
    v_add_f32 v52, v52, v11
    v_add_f32 v53, v53, v11
    v_add_f32 v54, v54, v11
    v_add_f32 v55, v55, v11
    v_add_f32 v56, v56, v11
    v_add_f32 v57, v57, v11
    v_add_f32 v58, v58, v11
    v_add_f32 v59, v59, v11
    s_branch L_MRETA
L_MASKB:
    s_nop 12
    v_add_f32 v60, v60, v10
    v_add_f32 v61, v61, v10
    v_add_f32 v62, v62, v10
    v_add_f32 v63, v63, v10
    v_add_f32 v64, v64, v10
    v_add_f32 v65, v65, v10
    v_add_f32 v66, v66, v10
    v_add_f32 v67, v67, v10
    v_add_f32 v68, v68, v11
    v_add_f32 v69, v69, v11
    v_add_f32 v70, v70, v11
    v_add_f32 v71, v71, v11
    v_add_f32 v72, v72, v11
    v_add_f32 v73, v73, v11
    v_add_f32 v74, v74, v11
    v_add_f32 v75, v75, v11
    v_add_f32 v76, v76, v8
    v_add_f32 v77, v77, v8
    v_add_f32 v78, v78, v8
    v_add_f32 v79, v79, v8
    v_add_f32 v80, v80, v8
    v_add_f32 v81, v81, v8
    v_add_f32 v82, v82, v8
    v_add_f32 v83, v83, v8
    v_add_f32 v84, v84, v9
    v_add_f32 v85, v85, v9
    v_add_f32 v86, v86, v9
    v_add_f32 v87, v87, v9
    v_add_f32 v88, v88, v9
    v_add_f32 v89, v89, v9
    v_add_f32 v90, v90, v9
    v_add_f32 v91, v91, v9
    s_branch L_MRETB
L_MASKC:
    s_nop 12
    v_add_f32 v60, v60, v10
    v_add_f32 v61, v61, v10
    v_add_f32 v62, v62, v10
    v_add_f32 v63, v63, v10
    v_add_f32 v64, v64, v10
    v_add_f32 v65, v65, v10
    v_add_f32 v66, v66, v10
    v_add_f32 v67, v67, v10
    v_add_f32 v68, v68, v11
    v_add_f32 v69, v69, v11
    v_add_f32 v70, v70, v11
    v_add_f32 v71, v71, v11
    v_add_f32 v72, v72, v11
    v_add_f32 v73, v73, v11
    v_add_f32 v74, v74, v11
    v_add_f32 v75, v75, v11
    v_add_f32 v76, v76, v8
    v_add_f32 v77, v77, v8
    v_add_f32 v78, v78, v8
    v_add_f32 v79, v79, v8
    v_add_f32 v80, v80, v8
    v_add_f32 v81, v81, v8
    v_add_f32 v82, v82, v8
    v_add_f32 v83, v83, v8
    v_add_f32 v84, v84, v9
    v_add_f32 v85, v85, v9
    v_add_f32 v86, v86, v9
    v_add_f32 v87, v87, v9
    v_add_f32 v88, v88, v9
    v_add_f32 v89, v89, v9
    v_add_f32 v90, v90, v9
    v_add_f32 v91, v91, v9
    s_branch L_MRETC
    s_nop 0
L_B:
    s_setprio 2
    s_and_b32 s100, s4, 1
    s_lshl_b32 s100, s100, 2
    s_add_u32 s100, s100, 4
    s_lshr_b32 s101, s4, 1
    s_lshl_b32 s101, s101, 2
    s_add_u32 s101, s101, 4
    s_mov_b32 s5, 0
    v_add_u32 v80, 0, v0
    v_mul_u32_u24 v81, 43691, v80
    v_lshrrev_b32 v81, 20, v81
    v_mul_u32_u24 v82, 24, v81
    v_sub_u32 v82, v80, v82
    v_bfe_u32 v83, v81, 1, 2
    v_xor_b32 v84, v82, v83
    v_lshlrev_b32 v84, 4, v84
    v_lshrrev_b32 v83, 2, v81
    v_mul_u32_u24 v83, 147456, v83
    v_and_b32 v85, 3, v81
    v_mul_u32_u24 v85, 384, v85
    v_add3_u32 v1, v85, v84, v83
    s_add_i32 s30, s5, 0
    s_lshl_b32 s30, s30, 8
    s_add_u32 s30, s30, s2
    s_mul_i32 s28, s30, 43691
    s_lshr_b32 s28, s28, 21
    s_mul_i32 s29, s28, 48
    s_sub_u32 s29, s30, s29
    s_lshl_b32 s28, s28, 3
    s_add_u32 s28, s28, s100
    s_cmp_ge_u32 s28, 384
    s_cselect_b32 s28, 0, s28
    s_lshl_b32 s29, s29, 3
    s_add_u32 s29, s29, s101
    s_cmp_ge_u32 s29, 384
    s_cselect_b32 s29, 0, s29
    s_mul_i32 s28, s28, 147456
    s_mul_i32 s29, s29, 384
    s_add_u32 s38, s28, s29
    s_add_u32 s39, s38, 294912
    s_mul_i32 s33, s4, 6272
    v_add_u32 v80, 64, v0
    v_mul_u32_u24 v81, 43691, v80
    v_lshrrev_b32 v81, 20, v81
    v_mul_u32_u24 v82, 24, v81
    v_sub_u32 v82, v80, v82
    v_bfe_u32 v83, v81, 1, 2
    v_xor_b32 v84, v82, v83
    v_lshlrev_b32 v84, 4, v84
    v_lshrrev_b32 v83, 2, v81
    v_mul_u32_u24 v83, 147456, v83
    v_and_b32 v85, 3, v81
    v_mul_u32_u24 v85, 384, v85
    v_add3_u32 v2, v85, v84, v83
    v_subrev_u32 v2, 1024, v2
    v_add_u32 v80, 128, v0
    v_mul_u32_u24 v81, 43691, v80
    v_lshrrev_b32 v81, 20, v81
    v_mul_u32_u24 v82, 24, v81
    v_sub_u32 v82, v80, v82
    v_bfe_u32 v83, v81, 1, 2
    v_xor_b32 v84, v82, v83
    v_lshlrev_b32 v84, 4, v84
    v_lshrrev_b32 v83, 2, v81
    v_mul_u32_u24 v83, 147456, v83
    v_and_b32 v85, 3, v81
    v_mul_u32_u24 v85, 384, v85
    v_add3_u32 v3, v85, v84, v83
    v_subrev_u32 v3, 2048, v3
    s_waitcnt lgkmcnt(0)
    s_cmp_ge_u32 s4, 2
    s_cbranch_scc1 L_B_X0A
    s_add_u32 m0, s33, s7
    s_nop 0
    buffer_load_dwordx4 v1, s[8:11], s38 offen offset:0 lds
    buffer_load_dwordx4 v2, s[8:11], s38 offen offset:1024 lds
    buffer_load_dwordx4 v3, s[8:11], s38 offen offset:2048 lds
    s_add_u32 m0, m0, 3136
    s_nop 0
    buffer_load_dwordx4 v1, s[8:11], s39 offen offset:0 lds
    buffer_load_dwordx4 v2, s[8:11], s39 offen offset:1024 lds
    buffer_load_dwordx4 v3, s[8:11], s39 offen offset:2048 lds
L_B_X0A:
    v_add_u32 v80, 0, v0
    v_mul_u32_u24 v81, 43691, v80
    v_lshrrev_b32 v81, 21, v81
    v_mul_u32_u24 v82, 48, v81
    v_sub_u32 v82, v80, v82
    v_lshlrev_b32 v83, 1, v81
    v_xor_b32 v82, v82, v83
    v_mul_u32_u24 v83, 1152, v81
    v_lshl_add_u32 v64, v82, 4, v83
    v_add_u32 v80, 64, v0
    v_mul_u32_u24 v81, 43691, v80
    v_lshrrev_b32 v81, 21, v81
    v_mul_u32_u24 v82, 48, v81
    v_sub_u32 v82, v80, v82
    v_lshlrev_b32 v83, 1, v81
    v_xor_b32 v82, v82, v83
    v_mul_u32_u24 v83, 1152, v81
    v_lshl_add_u32 v65, v82, 4, v83
    v_subrev_u32 v65, 1024, v65
    v_add_u32 v80, 128, v0
    v_mul_u32_u24 v81, 43691, v80
    v_lshrrev_b32 v81, 21, v81
    v_mul_u32_u24 v82, 48, v81
    v_sub_u32 v82, v80, v82
    v_lshlrev_b32 v83, 1, v81
    v_xor_b32 v82, v82, v83
    v_mul_u32_u24 v83, 1152, v81
    v_lshl_add_u32 v66, v82, 4, v83
    v_subrev_u32 v66, 2048, v66
    s_mul_i32 s34, s4, 6144
    s_mul_i32 s35, s4, 9216
    s_mul_i32 s36, s4, 18432
    s_add_u32 m0, s34, 50176
    s_add_u32 s31, s35, 0
    buffer_load_dwordx4 v64, s[16:19], s31 offen offset:0 lds
    buffer_load_dwordx4 v65, s[16:19], s31 offen offset:1024 lds
    buffer_load_dwordx4 v66, s[16:19], s31 offen offset:2048 lds
    s_add_u32 m0, s34, 53248
    s_add_u32 s31, s35, 4608
    buffer_load_dwordx4 v64, s[16:19], s31 offen offset:0 lds
    buffer_load_dwordx4 v65, s[16:19], s31 offen offset:1024 lds
    buffer_load_dwordx4 v66, s[16:19], s31 offen offset:2048 lds
    s_add_u32 m0, s34, 75264
    s_add_u32 s31, s35, 36864
    buffer_load_dwordx4 v64, s[16:19], s31 offen offset:0 lds
    buffer_load_dwordx4 v65, s[16:19], s31 offen offset:1024 lds
    buffer_load_dwordx4 v66, s[16:19], s31 offen offset:2048 lds
    s_add_u32 m0, s34, 78336
    s_add_u32 s31, s35, 41472
    buffer_load_dwordx4 v64, s[16:19], s31 offen offset:0 lds
    buffer_load_dwordx4 v65, s[16:19], s31 offen offset:1024 lds
    buffer_load_dwordx4 v66, s[16:19], s31 offen offset:2048 lds
    v_add_u32 v80, 0, v0
    v_mul_u32_u24 v81, 43691, v80
    v_lshrrev_b32 v81, 20, v81
    v_mul_u32_u24 v82, 24, v81
    v_sub_u32 v82, v80, v82
    v_and_b32 v83, 2, v81
    v_xor_b32 v84, v82, v83
    v_mul_u32_u24 v83, 1152, v81
    v_lshl_add_u32 v67, v84, 4, v83
    v_add_u32 v67, 768, v67
    v_xor_b32 v70, 64, v67
    v_add_u32 v80, 64, v0
    v_mul_u32_u24 v81, 43691, v80
    v_lshrrev_b32 v81, 20, v81
    v_mul_u32_u24 v82, 24, v81
    v_sub_u32 v82, v80, v82
    v_and_b32 v83, 2, v81
    v_xor_b32 v84, v82, v83
    v_mul_u32_u24 v83, 1152, v81
    v_lshl_add_u32 v68, v84, 4, v83
    v_add_u32 v68, 4294967040, v68
    v_xor_b32 v71, 64, v68
    v_add_u32 v80, 128, v0
    v_mul_u32_u24 v81, 43691, v80
    v_lshrrev_b32 v81, 20, v81
    v_mul_u32_u24 v82, 24, v81
    v_sub_u32 v82, v80, v82
    v_and_b32 v83, 2, v81
    v_xor_b32 v84, v82, v83
    v_mul_u32_u24 v83, 1152, v81
    v_lshl_add_u32 v69, v84, 4, v83
    v_add_u32 v69, 4294966016, v69
    v_xor_b32 v72, 64, v69
    s_mul_i32 s29, s4, 3072
    s_add_u32 s29, s29, 144128
    v_lshlrev_b32 v80, 4, v0
    v_add_u32 v46, s29, v80
    v_lshrrev_b32 v81, 4, v0
    v_bfe_u32 v82, v0, 2, 2
    v_and_b32 v83, 3, v0
    v_lshl_add_u32 v84, v81, 3, v82
    v_mul_u32_u24 v84, 384, v84
    v_lshl_add_u32 v84, v83, 3, v84
    v_add_u32 v84, 111360, v84
    v_bfe_u32 v85, v0, 3, 2
    s_mul_i32 s28, s4, 3
    s_add_u32 s30, s28, 0
    v_xor_b32 v86, s30, v85
    v_lshl_add_u32 v50, v86, 5, v84
    s_add_u32 s30, s28, 1
    v_xor_b32 v86, s30, v85
    v_lshl_add_u32 v51, v86, 5, v84
    s_add_u32 s30, s28, 2
    v_xor_b32 v86, s30, v85
    v_lshl_add_u32 v52, v86, 5, v84
    v_lshl_add_u32 v84, v81, 2, v82
    v_mul_u32_u24 v84, 96, v84
    v_add_u32 v84, s29, v84
    v_lshl_add_u32 v47, v83, 4, v84
    v_lshl_add_u32 v48, v83, 3, v84
    v_bfe_u32 v84, v0, 3, 1
    v_mul_u32_u24 v84, 3136, v84
    v_and_b32 v85, 7, v0
    v_mul_u32_u24 v85, 384, v85
    v_add_u32 v84, v84, v85
    v_bfe_u32 v85, v0, 1, 2
    v_xor_b32 v86, v81, v85
    v_lshl_add_u32 v4, v86, 4, v84
    s_lshl_b32 s30, s4, 6
    v_add_u32 v9, s30, v4
    s_lshl_b32 s30, s4, 1
    s_add_u32 s30, s30, 16
    v_lshrrev_b32 v86, 1, v81
    v_add_u32 v86, s30, v86
    v_xor_b32 v86, v86, v85
    v_lshl_add_u32 v10, v86, 4, v84
    v_and_b32 v86, 1, v81
    v_lshl_add_u32 v10, v86, 3, v10
    v_add_u32 v5, 75264, v80
    s_lshl_b32 s30, s4, 12
    v_add_u32 v6, s30, v5
    s_lshr_b32 s30, s4, 1
    s_add_u32 s30, s30, 4
    s_lshl_b32 s30, s30, 12
    s_and_b32 s31, s4, 1
    s_lshl_b32 s31, s31, 3
    s_add_u32 s30, s30, s31
    v_add_u32 v7, s30, v5
    v_and_b32 v86, 15, v0
    v_lshlrev_b32 v86, 4, v86
    v_lshl_add_u32 v8, v81, 10, v86
    s_lshl_b32 s30, s4, 13
    s_add_u32 s30, s30, 111360
    v_add_u32 v8, s30, v8
    v_mov_b32 v12, 0x3f803f80
    v_mov_b32 v13, 0x3f803f80
    v_mov_b32 v14, 0x3f803f80
    v_mov_b32 v15, 0x3f803f80
    s_lshl_b32 s30, s4, 5
    s_sub_u32 s30, 192, s30
    v_mov_b32 v85, s30
    v_add_u32 v80, 0, v0
    v_mul_u32_u24 v81, 43691, v80
    v_lshrrev_b32 v81, 18, v81
    v_mul_u32_u24 v82, 6, v81
    v_sub_u32 v82, v80, v82
    v_cmp_le_u32 vcc, 4, v82
    s_nop 1
    v_cndmask_b32 v84, 0, v85, vcc
    v_lshl_add_u32 v82, v82, 4, v84
    v_mul_u32_u24 v83, 384, v81
    v_add_u32 v73, v83, v82
    v_lshrrev_b32 v83, 4, v81
    v_mul_u32_u24 v83, 12288, v83
    v_add_u32 v76, v73, v83
    v_add_u32 v80, 64, v0
    v_mul_u32_u24 v81, 43691, v80
    v_lshrrev_b32 v81, 18, v81
    v_mul_u32_u24 v82, 6, v81
    v_sub_u32 v82, v80, v82
    v_cmp_le_u32 vcc, 4, v82
    s_nop 1
    v_cndmask_b32 v84, 0, v85, vcc
    v_lshl_add_u32 v82, v82, 4, v84
    v_mul_u32_u24 v83, 384, v81
    v_add_u32 v74, v83, v82
    v_lshrrev_b32 v83, 4, v81
    v_mul_u32_u24 v83, 12288, v83
    v_add_u32 v77, v74, v83
    v_add_u32 v80, 128, v0
    v_mul_u32_u24 v81, 43691, v80
    v_lshrrev_b32 v81, 18, v81
    v_mul_u32_u24 v82, 6, v81
    v_sub_u32 v82, v80, v82
    v_cmp_le_u32 vcc, 4, v82
    s_nop 1
    v_cndmask_b32 v84, 0, v85, vcc
    v_lshl_add_u32 v82, v82, 4, v84
    v_mul_u32_u24 v83, 384, v81
    v_add_u32 v75, v83, v82
    v_lshrrev_b32 v83, 4, v81
    v_mul_u32_u24 v83, 12288, v83
    v_add_u32 v78, v75, v83
    s_mov_b32 s41, 25088
    s_add_u32 m0, s34, 111360
    s_add_u32 s31, s35, 73728
    buffer_load_dwordx4 v64, s[16:19], s31 offen offset:0 lds
    buffer_load_dwordx4 v65, s[16:19], s31 offen offset:1024 lds
    buffer_load_dwordx4 v66, s[16:19], s31 offen offset:2048 lds
    s_add_u32 m0, s34, 114432
    s_add_u32 s31, s35, 78336
    buffer_load_dwordx4 v64, s[16:19], s31 offen offset:0 lds
    buffer_load_dwordx4 v65, s[16:19], s31 offen offset:1024 lds
    buffer_load_dwordx4 v66, s[16:19], s31 offen offset:2048 lds
    s_cmp_lt_u32 s4, 2
    s_cbranch_scc1 L_B_X0B
    s_add_u32 m0, s33, s7
    s_nop 0
    buffer_load_dwordx4 v1, s[8:11], s38 offen offset:0 lds
    buffer_load_dwordx4 v2, s[8:11], s38 offen offset:1024 lds
    buffer_load_dwordx4 v3, s[8:11], s38 offen offset:2048 lds
    s_add_u32 m0, m0, 3136
    s_nop 0
    buffer_load_dwordx4 v1, s[8:11], s39 offen offset:0 lds
    buffer_load_dwordx4 v2, s[8:11], s39 offen offset:1024 lds
    buffer_load_dwordx4 v3, s[8:11], s39 offen offset:2048 lds
L_B_X0B:
    s_mov_b32 s40, s38
    s_add_i32 s30, s5, 1
    s_lshl_b32 s30, s30, 8
    s_add_u32 s30, s30, s2
    s_mul_i32 s28, s30, 43691
    s_lshr_b32 s28, s28, 21
    s_mul_i32 s29, s28, 48
    s_sub_u32 s29, s30, s29
    s_lshl_b32 s28, s28, 3
    s_add_u32 s28, s28, s100
    s_cmp_ge_u32 s28, 384
    s_cselect_b32 s28, 0, s28
    s_lshl_b32 s29, s29, 3
    s_add_u32 s29, s29, s101
    s_cmp_ge_u32 s29, 384
    s_cselect_b32 s29, 0, s29
    s_mul_i32 s28, s28, 147456
    s_mul_i32 s29, s29, 384
    s_add_u32 s38, s28, s29
    s_add_u32 s39, s38, 294912
    s_mov_b32 s37, s38
    s_cmp_ge_u32 s4, 2
    s_waitcnt vmcnt(18)
    s_cbranch_scc1 L_B_WG0
    s_waitcnt vmcnt(12)
L_B_WG0:
    s_barrier
    s_add_u32 m0, s34, 135936
    s_add_u32 s31, s35, 110592
    buffer_load_dwordx4 v64, s[16:19], s31 offen offset:0 lds
    buffer_load_dwordx4 v65, s[16:19], s31 offen offset:1024 lds
    buffer_load_dwordx4 v66, s[16:19], s31 offen offset:2048 lds
    s_add_u32 m0, s34, 139008
    s_add_u32 s31, s35, 115200
    buffer_load_dwordx4 v64, s[16:19], s31 offen offset:0 lds
    buffer_load_dwordx4 v65, s[16:19], s31 offen offset:1024 lds
    buffer_load_dwordx4 v66, s[16:19], s31 offen offset:2048 lds
    s_cmp_ge_u32 s4, 2
    s_waitcnt vmcnt(18)
    s_cbranch_scc1 L_B_WG1
    s_waitcnt vmcnt(12)
L_B_WG1:
    s_barrier
    s_add_u32 m0, s34, 50176
    s_add_u32 s31, s35, 147456
    buffer_load_dwordx4 v64, s[16:19], s31 offen offset:0 lds
    buffer_load_dwordx4 v65, s[16:19], s31 offen offset:1024 lds
    buffer_load_dwordx4 v66, s[16:19], s31 offen offset:2048 lds
    s_add_u32 m0, s34, 53248
    s_add_u32 s31, s35, 152064
    buffer_load_dwordx4 v64, s[16:19], s31 offen offset:0 lds
    buffer_load_dwordx4 v65, s[16:19], s31 offen offset:1024 lds
    buffer_load_dwordx4 v66, s[16:19], s31 offen offset:2048 lds
    s_cmp_ge_u32 s4, 2
    s_waitcnt vmcnt(18)
    s_cbranch_scc1 L_B_WG2
    s_waitcnt vmcnt(12)
L_B_WG2:
    s_barrier
    s_add_u32 m0, s34, 75264
    s_add_u32 s31, s35, 184320
    buffer_load_dwordx4 v64, s[16:19], s31 offen offset:0 lds
    buffer_load_dwordx4 v65, s[16:19], s31 offen offset:1024 lds
    buffer_load_dwordx4 v66, s[16:19], s31 offen offset:2048 lds
    s_add_u32 m0, s34, 78336
    s_add_u32 s31, s35, 188928
    buffer_load_dwordx4 v64, s[16:19], s31 offen offset:0 lds
    buffer_load_dwordx4 v65, s[16:19], s31 offen offset:1024 lds
    buffer_load_dwordx4 v66, s[16:19], s31 offen offset:2048 lds
    s_waitcnt vmcnt(12)
    s_barrier
    s_add_u32 m0, s34, 111360
    s_add_u32 s31, s36, 0
    buffer_load_dwordx4 v67, s[16:19], s31 offen offset:0 lds
    buffer_load_dwordx4 v68, s[16:19], s31 offen offset:1024 lds
    buffer_load_dwordx4 v69, s[16:19], s31 offen offset:2048 lds
    s_add_u32 m0, s34, 114432
    s_add_u32 s31, s36, 9216
    buffer_load_dwordx4 v70, s[16:19], s31 offen offset:0 lds
    buffer_load_dwordx4 v71, s[16:19], s31 offen offset:1024 lds
    buffer_load_dwordx4 v72, s[16:19], s31 offen offset:2048 lds
    s_waitcnt vmcnt(12)
    s_barrier
    s_add_u32 m0, s34, 135936
    s_add_u32 s31, s36, 73728
    buffer_load_dwordx4 v67, s[16:19], s31 offen offset:0 lds
    buffer_load_dwordx4 v68, s[16:19], s31 offen offset:1024 lds
    buffer_load_dwordx4 v69, s[16:19], s31 offen offset:2048 lds
    s_add_u32 m0, s34, 139008
    s_add_u32 s31, s36, 82944
    buffer_load_dwordx4 v70, s[16:19], s31 offen offset:0 lds
    buffer_load_dwordx4 v71, s[16:19], s31 offen offset:1024 lds
    buffer_load_dwordx4 v72, s[16:19], s31 offen offset:2048 lds
    s_waitcnt vmcnt(12)
    s_barrier
    s_add_u32 m0, s34, 50176
    s_add_u32 s31, s36, 147456
    buffer_load_dwordx4 v67, s[16:19], s31 offen offset:0 lds
    buffer_load_dwordx4 v68, s[16:19], s31 offen offset:1024 lds
    buffer_load_dwordx4 v69, s[16:19], s31 offen offset:2048 lds
    s_add_u32 m0, s34, 53248
    s_add_u32 s31, s36, 156672
    buffer_load_dwordx4 v70, s[16:19], s31 offen offset:0 lds
    buffer_load_dwordx4 v71, s[16:19], s31 offen offset:1024 lds
    buffer_load_dwordx4 v72, s[16:19], s31 offen offset:2048 lds
    s_mov_b32 s7, 25088
    s_add_u32 m0, s33, s7
    s_nop 0
    buffer_load_dwordx4 v1, s[8:11], s38 offen offset:0 lds
    buffer_load_dwordx4 v2, s[8:11], s38 offen offset:1024 lds
    buffer_load_dwordx4 v3, s[8:11], s38 offen offset:2048 lds
    s_add_u32 m0, m0, 3136
    s_nop 0
    buffer_load_dwordx4 v1, s[8:11], s39 offen offset:0 lds
    buffer_load_dwordx4 v2, s[8:11], s39 offen offset:1024 lds
    buffer_load_dwordx4 v3, s[8:11], s39 offen offset:2048 lds
    s_mov_b32 s7, 0
    s_barrier
    s_mov_b32 s36, s40
    s_lshr_b32 s40, s34, 1
    s_add_u32 s30, s40, 4294898432
    s_add_u32 s40, s40, 144128
    v_mov_b32 v65, v47
    v_mov_b32 v66, v48
    v_add_u32 v64, s30, v47
    v_add_u32 v79, s30, v48
    s_waitcnt vmcnt(6)
    s_barrier
    ds_read_b64_tr_b16 v[112:113], v50 offset:0
    ds_read_b64_tr_b16 v[114:115], v50 offset:1536
    ds_read_b64_tr_b16 v[116:117], v51 offset:0
    ds_read_b64_tr_b16 v[118:119], v51 offset:1536
    ds_read_b64_tr_b16 v[120:121], v52 offset:0
    ds_read_b64_tr_b16 v[122:123], v52 offset:1536
    ds_read_b64_tr_b16 v[124:125], v50 offset:12288
    ds_read_b64_tr_b16 v[126:127], v50 offset:13824
    ds_read_b64_tr_b16 v[128:129], v51 offset:12288
    ds_read_b64_tr_b16 v[130:131], v51 offset:13824
    ds_read_b64_tr_b16 v[132:133], v52 offset:12288
    ds_read_b64_tr_b16 v[134:135], v52 offset:13824
    ds_read_b64_tr_b16 v[136:137], v50 offset:24576
    ds_read_b64_tr_b16 v[138:139], v50 offset:26112
    ds_read_b64_tr_b16 v[140:141], v51 offset:24576
    ds_read_b64_tr_b16 v[142:143], v51 offset:26112
    ds_read_b64_tr_b16 v[144:145], v52 offset:24576
    ds_read_b64_tr_b16 v[146:147], v52 offset:26112
    ds_read_b64_tr_b16 v[148:149], v50 offset:36864
    ds_read_b64_tr_b16 v[150:151], v50 offset:38400
    ds_read_b64_tr_b16 v[152:153], v51 offset:36864
    ds_read_b64_tr_b16 v[154:155], v51 offset:38400
    ds_read_b64_tr_b16 v[156:157], v52 offset:36864
    ds_read_b64_tr_b16 v[158:159], v52 offset:38400
    v_add_u32 v50, 4294906112, v50
    v_add_u32 v51, 4294906112, v51
    v_add_u32 v52, 4294906112, v52
    ds_read_b64_tr_b16 v[160:161], v50 offset:0
    ds_read_b64_tr_b16 v[162:163], v50 offset:1536
    ds_read_b64_tr_b16 v[164:165], v51 offset:0
    ds_read_b64_tr_b16 v[166:167], v51 offset:1536
    ds_read_b64_tr_b16 v[168:169], v52 offset:0
    ds_read_b64_tr_b16 v[170:171], v52 offset:1536
    ds_read_b64_tr_b16 v[172:173], v50 offset:12288
    ds_read_b64_tr_b16 v[174:175], v50 offset:13824
    ds_read_b64_tr_b16 v[176:177], v51 offset:12288
    ds_read_b64_tr_b16 v[178:179], v51 offset:13824
    ds_read_b64_tr_b16 v[180:181], v52 offset:12288
    ds_read_b64_tr_b16 v[182:183], v52 offset:13824
    s_waitcnt lgkmcnt(0)
    ds_read_b128 v[40:43], v4 offset:0
    ds_read_b128 v[44:47], v4 offset:64
    ds_read_b128 v[48:51], v4 offset:128
    ds_read_b128 v[52:55], v4 offset:192
    ds_read_b128 v[56:59], v4 offset:256
    ds_read_b128 v[60:63], v4 offset:320
    s_setprio 0
    s_waitcnt lgkmcnt(5)
    v_mfma_f32_16x16x32_bf16 v[80:83], v[40:43], v[112:115], 0
    s_lshl_b32 s31, s4, 6
    s_add_u32 m0, s34, 75264
    s_nop 0
    buffer_load_dwordx4 v73, s[20:23], s31 offen lds
    v_mfma_f32_16x16x32_bf16 v[84:87], v[40:43], v[116:119], 0
    v_mfma_f32_16x16x32_bf16 v[88:91], v[40:43], v[120:123], 0
    ds_read_b128 v[40:43], v4 offset:6272
    s_waitcnt lgkmcnt(5)
    v_mfma_f32_16x16x32_bf16 v[80:83], v[44:47], v[124:127], v[80:83]
    s_add_u32 m0, s34, 76288
    s_nop 0
    buffer_load_dwordx4 v74, s[20:23], s31 offen lds
    v_mfma_f32_16x16x32_bf16 v[84:87], v[44:47], v[128:131], v[84:87]
    v_mfma_f32_16x16x32_bf16 v[88:91], v[44:47], v[132:135], v[88:91]
    ds_read_b128 v[44:47], v4 offset:6336
    s_waitcnt lgkmcnt(5)
    v_mfma_f32_16x16x32_bf16 v[80:83], v[48:51], v[136:139], v[80:83]
    s_add_u32 m0, s34, 77312
    s_nop 0
    buffer_load_dwordx4 v75, s[20:23], s31 offen lds
    v_mfma_f32_16x16x32_bf16 v[84:87], v[48:51], v[140:143], v[84:87]
    v_mfma_f32_16x16x32_bf16 v[88:91], v[48:51], v[144:147], v[88:91]
    ds_read_b128 v[48:51], v4 offset:6400
    s_waitcnt lgkmcnt(5)
    v_mfma_f32_16x16x32_bf16 v[80:83], v[52:55], v[148:151], v[80:83]
    s_add_u32 s31, s31, 18432
    s_add_u32 m0, s34, 78336
    s_nop 0
    buffer_load_dwordx4 v73, s[20:23], s31 offen lds
    v_mfma_f32_16x16x32_bf16 v[84:87], v[52:55], v[152:155], v[84:87]
    v_mfma_f32_16x16x32_bf16 v[88:91], v[52:55], v[156:159], v[88:91]
    ds_read_b128 v[52:55], v4 offset:6464
    s_waitcnt lgkmcnt(5)
    v_mfma_f32_16x16x32_bf16 v[80:83], v[56:59], v[160:163], v[80:83]
    s_add_u32 m0, s34, 79360
    s_nop 0
    buffer_load_dwordx4 v74, s[20:23], s31 offen lds
    v_mfma_f32_16x16x32_bf16 v[84:87], v[56:59], v[164:167], v[84:87]
    v_mfma_f32_16x16x32_bf16 v[88:91], v[56:59], v[168:171], v[88:91]
    ds_read_b128 v[56:59], v4 offset:6528
    s_waitcnt lgkmcnt(5)
    v_mfma_f32_16x16x32_bf16 v[80:83], v[60:63], v[172:175], v[80:83]
    s_add_u32 m0, s34, 80384
    s_nop 0
    buffer_load_dwordx4 v75, s[20:23], s31 offen lds
    v_mfma_f32_16x16x32_bf16 v[84:87], v[60:63], v[176:179], v[84:87]
    v_mfma_f32_16x16x32_bf16 v[88:91], v[60:63], v[180:183], v[88:91]
    ds_read_b128 v[60:63], v4 offset:6592
    s_waitcnt lgkmcnt(5)
    v_mfma_f32_16x16x32_bf16 v[96:99], v[40:43], v[112:115], 0
    v_mfma_f32_16x16x32_bf16 v[100:103], v[40:43], v[116:119], 0
    v_mfma_f32_16x16x32_bf16 v[104:107], v[40:43], v[120:123], 0
    ds_read_b128 v[40:43], v4 offset:12544
    s_waitcnt lgkmcnt(5)
    v_mfma_f32_16x16x32_bf16 v[96:99], v[44:47], v[124:127], v[96:99]
    v_cvt_pk_bf16_f32 v16, v80, v81
    v_mfma_f32_16x16x32_bf16 v[100:103], v[44:47], v[128:131], v[100:103]
    v_cvt_pk_bf16_f32 v17, v82, v83
    v_mfma_f32_16x16x32_bf16 v[104:107], v[44:47], v[132:135], v[104:107]
    ds_read_b128 v[44:47], v4 offset:12608
    v_cvt_pk_bf16_f32 v24, v84, v85
    s_waitcnt lgkmcnt(5)
    v_mfma_f32_16x16x32_bf16 v[96:99], v[48:51], v[136:139], v[96:99]
    v_cvt_pk_bf16_f32 v25, v86, v87
    v_mfma_f32_16x16x32_bf16 v[100:103], v[48:51], v[140:143], v[100:103]
    v_cvt_pk_bf16_f32 v32, v88, v89
    v_mfma_f32_16x16x32_bf16 v[104:107], v[48:51], v[144:147], v[104:107]
    ds_read_b128 v[48:51], v4 offset:12672
    v_cvt_pk_bf16_f32 v33, v90, v91
    s_waitcnt lgkmcnt(5)
    v_mfma_f32_16x16x32_bf16 v[96:99], v[52:55], v[148:151], v[96:99]
    v_mfma_f32_16x16x32_bf16 v[100:103], v[52:55], v[152:155], v[100:103]
    v_mfma_f32_16x16x32_bf16 v[104:107], v[52:55], v[156:159], v[104:107]
    ds_read_b128 v[52:55], v4 offset:12736
    s_waitcnt lgkmcnt(5)
    v_mfma_f32_16x16x32_bf16 v[96:99], v[56:59], v[160:163], v[96:99]
    s_add_i32 s30, s5, 2
    s_lshl_b32 s30, s30, 8
    s_add_u32 s30, s30, s2
    s_mul_i32 s28, s30, 43691
    s_lshr_b32 s28, s28, 21
    s_mul_i32 s29, s28, 48
    s_sub_u32 s29, s30, s29
    s_lshl_b32 s28, s28, 3
    s_add_u32 s28, s28, s100
    s_cmp_ge_u32 s28, 384
    s_cselect_b32 s28, 0, s28
    s_lshl_b32 s29, s29, 3
    s_add_u32 s29, s29, s101
    s_cmp_ge_u32 s29, 384
    s_cselect_b32 s29, 0, s29
    s_mul_i32 s28, s28, 147456
    s_mul_i32 s29, s29, 384
    s_add_u32 s38, s28, s29
    s_add_u32 s39, s38, 294912
    s_waitcnt vmcnt(6)
    s_barrier
    v_mfma_f32_16x16x32_bf16 v[100:103], v[56:59], v[164:167], v[100:103]
    s_add_u32 s31, s31, 18432
    s_add_u32 m0, s40, 0
    s_nop 0
    buffer_load_dwordx4 v73, s[20:23], s31 offen lds
    v_mfma_f32_16x16x32_bf16 v[104:107], v[56:59], v[168:171], v[104:107]
    ds_read_b128 v[56:59], v4 offset:12800
    s_add_u32 m0, s40, 1024
    s_nop 0
    buffer_load_dwordx4 v74, s[20:23], s31 offen lds
    s_waitcnt lgkmcnt(5)
    v_mfma_f32_16x16x32_bf16 v[96:99], v[60:63], v[172:175], v[96:99]
    s_add_u32 m0, s40, 2048
    s_nop 0
    buffer_load_dwordx4 v75, s[20:23], s31 offen lds
    v_mfma_f32_16x16x32_bf16 v[100:103], v[60:63], v[176:179], v[100:103]
    v_mfma_f32_16x16x32_bf16 v[104:107], v[60:63], v[180:183], v[104:107]
    ds_read_b128 v[60:63], v4 offset:12864
    s_waitcnt vmcnt(3)
    ds_read_b64_tr_b16 v[184:185], v64 offset:0
    ds_read_b64_tr_b16 v[186:187], v64 offset:1536
    s_waitcnt lgkmcnt(7)
    v_mfma_f32_16x16x32_bf16 v[80:83], v[40:43], v[112:115], 0
    ds_read_b64_tr_b16 v[188:189], v64 offset:8
    ds_read_b64_tr_b16 v[190:191], v64 offset:1544
    v_mfma_f32_16x16x32_bf16 v[84:87], v[40:43], v[116:119], 0
    ds_read_b64_tr_b16 v[192:193], v79 offset:64
    ds_read_b64_tr_b16 v[194:195], v79 offset:1600
    v_mfma_f32_16x16x32_bf16 v[88:91], v[40:43], v[120:123], 0
    ds_read_b128 v[40:43], v4 offset:18816
    ds_read_b64_tr_b16 v[196:197], v64 offset:3072
    ds_read_b64_tr_b16 v[198:199], v64 offset:4608
    s_waitcnt lgkmcnt(13)
    v_mfma_f32_16x16x32_bf16 v[80:83], v[44:47], v[124:127], v[80:83]
    ds_read_b64_tr_b16 v[200:201], v64 offset:3080
    ds_read_b64_tr_b16 v[202:203], v64 offset:4616
    v_cvt_pk_bf16_f32 v18, v96, v97
    v_mfma_f32_16x16x32_bf16 v[84:87], v[44:47], v[128:131], v[84:87]
    ds_read_b64_tr_b16 v[204:205], v79 offset:3136
    ds_read_b64_tr_b16 v[206:207], v79 offset:4672
    v_cvt_pk_bf16_f32 v19, v98, v99
    v_mfma_f32_16x16x32_bf16 v[88:91], v[44:47], v[132:135], v[88:91]
    ds_read_b128 v[44:47], v4 offset:18880
    v_cvt_pk_bf16_f32 v26, v100, v101
    s_waitcnt lgkmcnt(15)
    v_mfma_f32_16x16x32_bf16 v[80:83], v[48:51], v[136:139], v[80:83]
    v_cvt_pk_bf16_f32 v27, v102, v103
    v_mfma_f32_16x16x32_bf16 v[84:87], v[48:51], v[140:143], v[84:87]
    s_waitcnt lgkmcnt(0)
    s_add_u32 s31, s31, 18432
    s_add_u32 m0, s34, 75264
    s_nop 0
    buffer_load_dwordx4 v73, s[20:23], s31 offen lds
    v_cvt_pk_bf16_f32 v34, v104, v105
    v_mfma_f32_16x16x32_bf16 v[88:91], v[48:51], v[144:147], v[88:91]
    ds_read_b128 v[48:51], v4 offset:18944
    s_add_u32 m0, s34, 76288
    s_nop 0
    buffer_load_dwordx4 v74, s[20:23], s31 offen lds
    v_cvt_pk_bf16_f32 v35, v106, v107
    v_mfma_f32_16x16x32_bf16 v[80:83], v[52:55], v[148:151], v[80:83]
    s_add_u32 m0, s34, 77312
    s_nop 0
    buffer_load_dwordx4 v75, s[20:23], s31 offen lds
    s_barrier
    v_mfma_f32_16x16x32_bf16 v[84:87], v[52:55], v[152:155], v[84:87]
    s_sub_u32 s31, s31, 43008
    s_add_u32 m0, s34, 78336
    s_nop 0
    buffer_load_dwordx4 v76, s[20:23], s31 offen lds
    v_mfma_f32_16x16x32_bf16 v[88:91], v[52:55], v[156:159], v[88:91]
    ds_read_b128 v[52:55], v4 offset:19008
    s_add_u32 m0, s34, 79360
    s_nop 0
    buffer_load_dwordx4 v77, s[20:23], s31 offen lds
    v_mfma_f32_16x16x32_bf16 v[80:83], v[56:59], v[160:163], v[80:83]
    s_add_u32 m0, s34, 80384
    s_nop 0
    buffer_load_dwordx4 v78, s[20:23], s31 offen lds
    s_waitcnt vmcnt(6)
    ds_read_b64_tr_b16 v[208:209], v65 offset:0
    ds_read_b64_tr_b16 v[210:211], v65 offset:1536
    v_mfma_f32_16x16x32_bf16 v[84:87], v[56:59], v[164:167], v[84:87]
    ds_read_b64_tr_b16 v[212:213], v65 offset:8
    ds_read_b64_tr_b16 v[214:215], v65 offset:1544
    v_mfma_f32_16x16x32_bf16 v[88:91], v[56:59], v[168:171], v[88:91]
    ds_read_b128 v[56:59], v4 offset:19072
    ds_read_b64_tr_b16 v[216:217], v66 offset:64
    ds_read_b64_tr_b16 v[218:219], v66 offset:1600
    v_mfma_f32_16x16x32_bf16 v[80:83], v[60:63], v[172:175], v[80:83]
    v_mfma_f32_16x16x32_bf16 v[84:87], v[60:63], v[176:179], v[84:87]
    v_mfma_f32_16x16x32_bf16 v[88:91], v[60:63], v[180:183], v[88:91]
    ds_read_b128 v[60:63], v4 offset:19136
    s_waitcnt lgkmcnt(0)
    s_add_u32 s31, s31, 36864
    s_add_u32 m0, s40, 0
    s_nop 0
    buffer_load_dwordx4 v76, s[20:23], s31 offen lds
    v_mfma_f32_16x16x32_bf16 v[96:99], v[40:43], v[112:115], 0
    s_add_u32 m0, s40, 1024
    s_nop 0
    buffer_load_dwordx4 v77, s[20:23], s31 offen lds
    v_mfma_f32_16x16x32_bf16 v[100:103], v[40:43], v[116:119], 0
    s_add_u32 m0, s40, 2048
    s_nop 0
    buffer_load_dwordx4 v78, s[20:23], s31 offen lds
    v_mfma_f32_16x16x32_bf16 v[104:107], v[40:43], v[120:123], 0
    v_mfma_f32_16x16x32_bf16 v[96:99], v[44:47], v[124:127], v[96:99]
    s_mov_b32 s7, 50176
    s_add_u32 m0, s33, s7
    v_cvt_pk_bf16_f32 v20, v80, v81
    v_mfma_f32_16x16x32_bf16 v[100:103], v[44:47], v[128:131], v[100:103]
    buffer_load_dwordx4 v1, s[8:11], s38 offen offset:0 lds
    v_cvt_pk_bf16_f32 v21, v82, v83
    v_mfma_f32_16x16x32_bf16 v[104:107], v[44:47], v[132:135], v[104:107]
    buffer_load_dwordx4 v2, s[8:11], s38 offen offset:1024 lds
    buffer_load_dwordx4 v3, s[8:11], s38 offen offset:2048 lds
    v_cvt_pk_bf16_f32 v28, v84, v85
    v_mfma_f32_16x16x32_bf16 v[96:99], v[48:51], v[136:139], v[96:99]
    s_add_u32 m0, m0, 3136
    v_cvt_pk_bf16_f32 v29, v86, v87
    v_mfma_f32_16x16x32_bf16 v[100:103], v[48:51], v[140:143], v[100:103]
    buffer_load_dwordx4 v1, s[8:11], s39 offen offset:0 lds
    v_cvt_pk_bf16_f32 v36, v88, v89
    v_mfma_f32_16x16x32_bf16 v[104:107], v[48:51], v[144:147], v[104:107]
    buffer_load_dwordx4 v2, s[8:11], s39 offen offset:1024 lds
    buffer_load_dwordx4 v3, s[8:11], s39 offen offset:2048 lds
    v_cvt_pk_bf16_f32 v37, v90, v91
    v_mfma_f32_16x16x32_bf16 v[96:99], v[52:55], v[148:151], v[96:99]
    s_mov_b32 s7, 0
    v_mfma_f32_16x16x32_bf16 v[100:103], v[52:55], v[152:155], v[100:103]
    s_mov_b32 s32, 25088
    v_mfma_f32_16x16x32_bf16 v[104:107], v[52:55], v[156:159], v[104:107]
    v_mfma_f32_16x16x32_bf16 v[96:99], v[56:59], v[160:163], v[96:99]
    v_mfma_f32_16x16x32_bf16 v[100:103], v[56:59], v[164:167], v[100:103]
    v_mfma_f32_16x16x32_bf16 v[104:107], v[56:59], v[168:171], v[104:107]
    v_mfma_f32_16x16x32_bf16 v[96:99], v[60:63], v[172:175], v[96:99]
    v_mfma_f32_16x16x32_bf16 v[100:103], v[60:63], v[176:179], v[100:103]
    v_mfma_f32_16x16x32_bf16 v[104:107], v[60:63], v[180:183], v[104:107]
    s_nop 1
    v_cvt_pk_bf16_f32 v22, v96, v97
    v_cvt_pk_bf16_f32 v23, v98, v99
    s_nop 0
    v_cvt_pk_bf16_f32 v30, v100, v101
    v_cvt_pk_bf16_f32 v31, v102, v103
    s_nop 0
    v_cvt_pk_bf16_f32 v38, v104, v105
    v_cvt_pk_bf16_f32 v39, v106, v107
    v_add_u32 v4, 25088, v4
    s_waitcnt vmcnt(12)
    ds_read_b64_tr_b16 v[220:221], v64 offset:0
    ds_read_b64_tr_b16 v[222:223], v64 offset:1536
    ds_read_b64_tr_b16 v[224:225], v64 offset:8
    ds_read_b64_tr_b16 v[226:227], v64 offset:1544
    ds_read_b64_tr_b16 v[228:229], v79 offset:64
    ds_read_b64_tr_b16 v[230:231], v79 offset:1600
    s_waitcnt vmcnt(9)
    ds_read_b64_tr_b16 v[232:233], v64 offset:3072
    ds_read_b64_tr_b16 v[234:235], v64 offset:4608
    ds_read_b64_tr_b16 v[236:237], v64 offset:3080
    ds_read_b64_tr_b16 v[238:239], v64 offset:4616
    ds_read_b64_tr_b16 v[240:241], v79 offset:3136
    ds_read_b64_tr_b16 v[242:243], v79 offset:4672
    s_waitcnt vmcnt(6)
    ds_read_b64_tr_b16 v[244:245], v65 offset:0
    ds_read_b64_tr_b16 v[246:247], v65 offset:1536
    ds_read_b64_tr_b16 v[248:249], v65 offset:8
    ds_read_b64_tr_b16 v[250:251], v65 offset:1544
    ds_read_b64_tr_b16 v[252:253], v66 offset:64
    ds_read_b64_tr_b16 v[254:255], v66 offset:1600
    ds_read_b128 v[40:43], v4 offset:0
    ds_read_b128 v[44:47], v4 offset:64
    ds_read_b128 v[48:51], v4 offset:128
    ds_read_b128 v[52:55], v4 offset:192
    ds_read_b128 v[56:59], v4 offset:256
    ds_read_b128 v[60:63], v4 offset:320
    s_mov_b32 s5, 1
    s_waitcnt lgkmcnt(0)
    s_barrier
    s_setprio 2
    ds_read_b128 v[64:67], v8 offset:0
    ds_read_b128 v[68:71], v8 offset:4096
    ds_read_b128 v[72:75], v8 offset:256
    ds_read_b128 v[76:79], v8 offset:4352
    s_branch L_B_J1
.p2align 3
L_B_LOOP:
    s_setprio 2
    ds_read_b128 v[64:67], v8 offset:0
    ds_read_b128 v[68:71], v8 offset:4096
    ds_read_b128 v[72:75], v8 offset:256
    ds_read_b128 v[76:79], v8 offset:4352
L_B_J1:
    s_waitcnt lgkmcnt(3)
    v_mfma_f32_16x16x32_bf16 v[92:95], v[12:15], v[64:67], 0
    v_mfma_f32_16x16x32_bf16 v[80:83], v[16:19], v[64:67], 0
    s_waitcnt lgkmcnt(2)
    v_mfma_f32_16x16x32_bf16 v[92:95], v[12:15], v[68:71], v[92:95]
    v_mfma_f32_16x16x32_bf16 v[80:83], v[20:23], v[68:71], v[80:83]
    v_mfma_f32_16x16x32_bf16 v[84:87], v[24:27], v[64:67], 0
    v_mfma_f32_16x16x32_bf16 v[88:91], v[32:35], v[64:67], 0
    ds_read_b128 v[64:67], v8 offset:512
    v_mfma_f32_16x16x32_bf16 v[84:87], v[28:31], v[68:71], v[84:87]
    v_mfma_f32_16x16x32_bf16 v[88:91], v[36:39], v[68:71], v[88:91]
    ds_read_b128 v[68:71], v8 offset:4608
    s_waitcnt lgkmcnt(3)
    v_mfma_f32_16x16x32_bf16 v[108:111], v[12:15], v[72:75], 0
    v_rcp_f32 v92, v92
    s_nop 0
    v_mul_f32 v80, v80, v92
    v_mfma_f32_16x16x32_bf16 v[96:99], v[16:19], v[72:75], 0
    v_mul_f32 v81, v81, v92
    v_mul_f32 v82, v82, v92
    v_mul_f32 v83, v83, v92
    s_waitcnt lgkmcnt(2)
    v_mfma_f32_16x16x32_bf16 v[108:111], v[12:15], v[76:79], v[108:111]
    v_cvt_pk_bf16_f32 v80, v80, v81
    v_cvt_pk_bf16_f32 v81, v82, v83
    v_mul_f32 v84, v84, v92
    v_mfma_f32_16x16x32_bf16 v[96:99], v[20:23], v[76:79], v[96:99]
    v_mul_f32 v85, v85, v92
    v_mul_f32 v86, v86, v92
    v_mfma_f32_16x16x32_bf16 v[100:103], v[24:27], v[72:75], 0
    v_mul_f32 v87, v87, v92
    v_cvt_pk_bf16_f32 v82, v84, v85
    v_cvt_pk_bf16_f32 v83, v86, v87
    v_mfma_f32_16x16x32_bf16 v[104:107], v[32:35], v[72:75], 0
    v_mul_f32 v88, v88, v92
    ds_write_b128 v6, v[80:83] offset:0
    v_mul_f32 v89, v89, v92
    ds_read_b128 v[72:75], v8 offset:768
    v_mfma_f32_16x16x32_bf16 v[100:103], v[28:31], v[76:79], v[100:103]
    v_mul_f32 v90, v90, v92
    v_mul_f32 v91, v91, v92
    v_cvt_pk_bf16_f32 v84, v88, v89
    v_mfma_f32_16x16x32_bf16 v[104:107], v[36:39], v[76:79], v[104:107]
    v_cvt_pk_bf16_f32 v85, v90, v91
    ds_write_b64 v7, v[84:85] offset:0
    ds_read_b128 v[76:79], v8 offset:4864
    s_waitcnt lgkmcnt(5)
    v_mfma_f32_16x16x32_bf16 v[92:95], v[12:15], v[64:67], 0
    v_rcp_f32 v108, v108
    s_nop 0
    v_mul_f32 v96, v96, v108
    v_mfma_f32_16x16x32_bf16 v[80:83], v[16:19], v[64:67], 0
    v_mul_f32 v97, v97, v108
    v_mul_f32 v98, v98, v108
    v_mul_f32 v99, v99, v108
    s_waitcnt lgkmcnt(4)
    v_mfma_f32_16x16x32_bf16 v[92:95], v[12:15], v[68:71], v[92:95]
    v_cvt_pk_bf16_f32 v96, v96, v97
    v_cvt_pk_bf16_f32 v97, v98, v99
    v_mul_f32 v100, v100, v108
    v_mfma_f32_16x16x32_bf16 v[80:83], v[20:23], v[68:71], v[80:83]
    v_mul_f32 v101, v101, v108
    v_mul_f32 v102, v102, v108
    v_mfma_f32_16x16x32_bf16 v[84:87], v[24:27], v[64:67], 0
    v_mul_f32 v103, v103, v108
    v_cvt_pk_bf16_f32 v98, v100, v101
    v_cvt_pk_bf16_f32 v99, v102, v103
    v_mfma_f32_16x16x32_bf16 v[88:91], v[32:35], v[64:67], 0
    v_mul_f32 v104, v104, v108
    ds_write_b128 v6, v[96:99] offset:1024
    v_mul_f32 v105, v105, v108
    v_mfma_f32_16x16x32_bf16 v[84:87], v[28:31], v[68:71], v[84:87]
    v_mul_f32 v106, v106, v108
    v_mul_f32 v107, v107, v108
    v_cvt_pk_bf16_f32 v100, v104, v105
    v_mfma_f32_16x16x32_bf16 v[88:91], v[36:39], v[68:71], v[88:91]
    v_cvt_pk_bf16_f32 v101, v106, v107
    ds_write_b64 v7, v[100:101] offset:1024
    s_waitcnt lgkmcnt(4)
    v_mfma_f32_16x16x32_bf16 v[108:111], v[12:15], v[72:75], 0
    v_rcp_f32 v92, v92
    s_nop 0
    v_mul_f32 v80, v80, v92
    v_mfma_f32_16x16x32_bf16 v[96:99], v[16:19], v[72:75], 0
    v_mul_f32 v81, v81, v92
    v_mul_f32 v82, v82, v92
    v_mul_f32 v83, v83, v92
    s_waitcnt lgkmcnt(2)
    v_mfma_f32_16x16x32_bf16 v[108:111], v[12:15], v[76:79], v[108:111]
    v_cvt_pk_bf16_f32 v80, v80, v81
    v_cvt_pk_bf16_f32 v81, v82, v83
    v_mul_f32 v84, v84, v92
    v_mfma_f32_16x16x32_bf16 v[96:99], v[20:23], v[76:79], v[96:99]
    v_mul_f32 v85, v85, v92
    v_mul_f32 v86, v86, v92
    v_mfma_f32_16x16x32_bf16 v[100:103], v[24:27], v[72:75], 0
    v_mul_f32 v87, v87, v92
    v_cvt_pk_bf16_f32 v82, v84, v85
    v_cvt_pk_bf16_f32 v83, v86, v87
    v_mfma_f32_16x16x32_bf16 v[104:107], v[32:35], v[72:75], 0
    v_mul_f32 v88, v88, v92
    ds_write_b128 v6, v[80:83] offset:2048
    v_mul_f32 v89, v89, v92
    v_mfma_f32_16x16x32_bf16 v[100:103], v[28:31], v[76:79], v[100:103]
    v_mul_f32 v90, v90, v92
    v_mul_f32 v91, v91, v92
    v_cvt_pk_bf16_f32 v84, v88, v89
    v_mfma_f32_16x16x32_bf16 v[104:107], v[36:39], v[76:79], v[104:107]
    v_cvt_pk_bf16_f32 v85, v90, v91
    ds_write_b64 v7, v[84:85] offset:2048
    s_setprio 2
    s_cmp_eq_u32 s5, 9
    s_cbranch_scc1 L_B_TAIL
    v_mfma_f32_16x16x32_bf16 v[80:83], v[40:43], v[112:115], 0
    v_rcp_f32 v108, v108
    s_nop 0
    v_mul_f32 v96, v96, v108
    v_mfma_f32_16x16x32_bf16 v[84:87], v[40:43], v[116:119], 0
    v_mul_f32 v97, v97, v108
    v_mul_f32 v98, v98, v108
    v_mfma_f32_16x16x32_bf16 v[88:91], v[40:43], v[120:123], 0
    ds_read_b128 v[40:43], v4 offset:6272
    v_mul_f32 v99, v99, v108
    v_cvt_pk_bf16_f32 v96, v96, v97
    v_mfma_f32_16x16x32_bf16 v[80:83], v[44:47], v[124:127], v[80:83]
    v_cvt_pk_bf16_f32 v97, v98, v99
    v_mul_f32 v100, v100, v108
    v_mfma_f32_16x16x32_bf16 v[84:87], v[44:47], v[128:131], v[84:87]
    v_mul_f32 v101, v101, v108
    v_mul_f32 v102, v102, v108
    v_mfma_f32_16x16x32_bf16 v[88:91], v[44:47], v[132:135], v[88:91]
    ds_read_b128 v[44:47], v4 offset:6336
    v_mul_f32 v103, v103, v108
    v_cvt_pk_bf16_f32 v98, v100, v101
    v_cvt_pk_bf16_f32 v99, v102, v103
    v_mfma_f32_16x16x32_bf16 v[80:83], v[48:51], v[136:139], v[80:83]
    v_mul_f32 v104, v104, v108
    ds_write_b128 v6, v[96:99] offset:3072
    v_mfma_f32_16x16x32_bf16 v[84:87], v[48:51], v[140:143], v[84:87]
    v_mul_f32 v105, v105, v108
    v_mul_f32 v106, v106, v108
    v_mfma_f32_16x16x32_bf16 v[88:91], v[48:51], v[144:147], v[88:91]
    ds_read_b128 v[48:51], v4 offset:6400
    v_mul_f32 v107, v107, v108
    v_cvt_pk_bf16_f32 v100, v104, v105
    v_mfma_f32_16x16x32_bf16 v[80:83], v[52:55], v[148:151], v[80:83]
    v_cvt_pk_bf16_f32 v101, v106, v107
    ds_write_b64 v7, v[100:101] offset:3072
    v_mfma_f32_16x16x32_bf16 v[84:87], v[52:55], v[152:155], v[84:87]
    s_add_u32 s31, s33, s7
    s_sub_u32 s31, s31, 75264
    v_add_u32 v11, s31, v5
    v_mfma_f32_16x16x32_bf16 v[88:91], v[52:55], v[156:159], v[88:91]
    ds_read_b128 v[52:55], v4 offset:6464
    s_add_u32 s31, s35, 294912
    ds_read_b128 v[64:67], v11 offset:0
    v_mfma_f32_16x16x32_bf16 v[80:83], v[56:59], v[160:163], v[80:83]
    ds_read_b128 v[68:71], v11 offset:1024
    ds_read_b128 v[72:75], v11 offset:2048
    v_mfma_f32_16x16x32_bf16 v[84:87], v[56:59], v[164:167], v[84:87]
    v_mfma_f32_16x16x32_bf16 v[88:91], v[56:59], v[168:171], v[88:91]
    ds_read_b128 v[56:59], v4 offset:6528
    v_mfma_f32_16x16x32_bf16 v[80:83], v[60:63], v[172:175], v[80:83]
    v_mfma_f32_16x16x32_bf16 v[84:87], v[60:63], v[176:179], v[84:87]
    v_mfma_f32_16x16x32_bf16 v[88:91], v[60:63], v[180:183], v[88:91]
    ds_read_b128 v[60:63], v4 offset:6592
    s_cmp_eq_u32 s5, 1
    s_waitcnt lgkmcnt(2)
    s_cbranch_scc1 L_B_NOST
    buffer_store_dwordx4 v[64:67], v1, s[12:15], s35 offen offset:0 sc0 sc1
    buffer_store_dwordx4 v[68:71], v2, s[12:15], s35 offen offset:1024 sc0 sc1
    buffer_store_dwordx4 v[72:75], v3, s[12:15], s35 offen offset:2048 sc0 sc1
L_B_NOST:
    ds_read_b128 v[64:67], v11 offset:3136
    ds_read_b128 v[68:71], v11 offset:4160
    ds_read_b128 v[72:75], v11 offset:5184
    v_mfma_f32_16x16x32_bf16 v[96:99], v[40:43], v[112:115], 0
    v_mfma_f32_16x16x32_bf16 v[100:103], v[40:43], v[116:119], 0
    v_mfma_f32_16x16x32_bf16 v[104:107], v[40:43], v[120:123], 0
    ds_read_b128 v[40:43], v4 offset:12544
    v_mfma_f32_16x16x32_bf16 v[96:99], v[44:47], v[124:127], v[96:99]
    v_cvt_pk_bf16_f32 v16, v80, v81
    v_mfma_f32_16x16x32_bf16 v[100:103], v[44:47], v[128:131], v[100:103]
    v_cvt_pk_bf16_f32 v17, v82, v83
    v_mfma_f32_16x16x32_bf16 v[104:107], v[44:47], v[132:135], v[104:107]
    ds_read_b128 v[44:47], v4 offset:12608
    s_cmp_eq_u32 s5, 1
    s_waitcnt lgkmcnt(2)
    s_cbranch_scc1 L_B_NOST2
    buffer_store_dwordx4 v[64:67], v1, s[12:15], s31 offen offset:0 sc0 sc1
    buffer_store_dwordx4 v[68:71], v2, s[12:15], s31 offen offset:1024 sc0 sc1
    buffer_store_dwordx4 v[72:75], v3, s[12:15], s31 offen offset:2048 sc0 sc1
L_B_NOST2:
    v_cvt_pk_bf16_f32 v24, v84, v85
    v_mfma_f32_16x16x32_bf16 v[96:99], v[48:51], v[136:139], v[96:99]
    s_mov_b32 s35, s36
    s_mov_b32 s36, s37
    v_cvt_pk_bf16_f32 v25, v86, v87
    v_mfma_f32_16x16x32_bf16 v[100:103], v[48:51], v[140:143], v[100:103]
    s_mov_b32 s37, s38
    s_add_i32 s30, s5, 2
    v_cvt_pk_bf16_f32 v32, v88, v89
    v_mfma_f32_16x16x32_bf16 v[104:107], v[48:51], v[144:147], v[104:107]
    ds_read_b128 v[48:51], v4 offset:12672
    s_lshl_b32 s30, s30, 8
    s_add_u32 s30, s30, s2
    v_cvt_pk_bf16_f32 v33, v90, v91
    v_mfma_f32_16x16x32_bf16 v[96:99], v[52:55], v[148:151], v[96:99]
    s_mul_i32 s28, s30, 43691
    s_lshr_b32 s28, s28, 21
    v_mfma_f32_16x16x32_bf16 v[100:103], v[52:55], v[152:155], v[100:103]
    s_mul_i32 s29, s28, 48
    s_sub_u32 s29, s30, s29
    v_mfma_f32_16x16x32_bf16 v[104:107], v[52:55], v[156:159], v[104:107]
    ds_read_b128 v[52:55], v4 offset:12736
    s_lshl_b32 s28, s28, 3
    v_mfma_f32_16x16x32_bf16 v[96:99], v[56:59], v[160:163], v[96:99]
    s_add_u32 s28, s28, s100
    s_cmp_ge_u32 s28, 384
    v_mfma_f32_16x16x32_bf16 v[100:103], v[56:59], v[164:167], v[100:103]
    s_cselect_b32 s28, 0, s28
    s_lshl_b32 s29, s29, 3
    v_mfma_f32_16x16x32_bf16 v[104:107], v[56:59], v[168:171], v[104:107]
    ds_read_b128 v[56:59], v4 offset:12800
    s_add_u32 s29, s29, s101
    s_cmp_ge_u32 s29, 384
    v_mfma_f32_16x16x32_bf16 v[96:99], v[60:63], v[172:175], v[96:99]
    s_cselect_b32 s29, 0, s29
    s_mul_i32 s28, s28, 147456
    v_mfma_f32_16x16x32_bf16 v[100:103], v[60:63], v[176:179], v[100:103]
    s_mul_i32 s29, s29, 384
    s_add_u32 s38, s28, s29
    v_mfma_f32_16x16x32_bf16 v[104:107], v[60:63], v[180:183], v[104:107]
    ds_read_b128 v[60:63], v4 offset:12864
    s_add_u32 s39, s38, 294912
    s_waitcnt lgkmcnt(5)
    v_mfma_f32_16x16x32_bf16 v[80:83], v[40:43], v[112:115], 0
    s_cmp_eq_u32 s5, 1
    s_cbranch_scc1 L_B_B9
L_B_B9R:
    s_cmp_ge_u32 s5, 7
    s_cbranch_scc1 L_B_NODMA
    s_add_u32 m0, s33, s7
    s_nop 0
    buffer_load_dwordx4 v1, s[8:11], s38 offen offset:0 lds
    buffer_load_dwordx4 v2, s[8:11], s38 offen offset:1024 lds
    buffer_load_dwordx4 v3, s[8:11], s38 offen offset:2048 lds
L_B_NODMA:
    v_mfma_f32_16x16x32_bf16 v[84:87], v[40:43], v[116:119], 0
    v_mfma_f32_16x16x32_bf16 v[88:91], v[40:43], v[120:123], 0
    ds_read_b128 v[40:43], v4 offset:18816
    s_waitcnt lgkmcnt(5)
    v_mfma_f32_16x16x32_bf16 v[80:83], v[44:47], v[124:127], v[80:83]
    v_cvt_pk_bf16_f32 v18, v96, v97
    v_mfma_f32_16x16x32_bf16 v[84:87], v[44:47], v[128:131], v[84:87]
    s_cmp_ge_u32 s5, 7
    s_cbranch_scc1 L_B_NODMA2
    s_add_u32 m0, m0, 3136
    s_nop 0
    buffer_load_dwordx4 v1, s[8:11], s39 offen offset:0 lds
    buffer_load_dwordx4 v2, s[8:11], s39 offen offset:1024 lds
    buffer_load_dwordx4 v3, s[8:11], s39 offen offset:2048 lds
L_B_NODMA2:
    v_cvt_pk_bf16_f32 v19, v98, v99
    v_mfma_f32_16x16x32_bf16 v[88:91], v[44:47], v[132:135], v[88:91]
    ds_read_b128 v[44:47], v4 offset:18880
    v_cvt_pk_bf16_f32 v26, v100, v101
    s_waitcnt lgkmcnt(5)
    v_mfma_f32_16x16x32_bf16 v[80:83], v[48:51], v[136:139], v[80:83]
    v_cvt_pk_bf16_f32 v27, v102, v103
    v_mfma_f32_16x16x32_bf16 v[84:87], v[48:51], v[140:143], v[84:87]
    v_cvt_pk_bf16_f32 v34, v104, v105
    v_mfma_f32_16x16x32_bf16 v[88:91], v[48:51], v[144:147], v[88:91]
    ds_read_b128 v[48:51], v4 offset:18944
    v_cvt_pk_bf16_f32 v35, v106, v107
    s_waitcnt lgkmcnt(5)
    v_mfma_f32_16x16x32_bf16 v[80:83], v[52:55], v[148:151], v[80:83]
    v_mfma_f32_16x16x32_bf16 v[84:87], v[52:55], v[152:155], v[84:87]
    v_mfma_f32_16x16x32_bf16 v[88:91], v[52:55], v[156:159], v[88:91]
    ds_read_b128 v[52:55], v4 offset:19008
    s_waitcnt lgkmcnt(5)
    v_mfma_f32_16x16x32_bf16 v[80:83], v[56:59], v[160:163], v[80:83]
    v_add_u32 v9, s32, v9
    v_mfma_f32_16x16x32_bf16 v[84:87], v[56:59], v[164:167], v[84:87]
    v_add_u32 v10, s32, v10
    v_mfma_f32_16x16x32_bf16 v[88:91], v[56:59], v[168:171], v[88:91]
    ds_read_b128 v[56:59], v4 offset:19072
    s_add_u32 s7, s7, 25088
    s_waitcnt lgkmcnt(5)
    v_mfma_f32_16x16x32_bf16 v[80:83], v[60:63], v[172:175], v[80:83]
    s_cmp_eq_u32 s7, 75264
    v_mfma_f32_16x16x32_bf16 v[84:87], v[60:63], v[176:179], v[84:87]
    s_cselect_b32 s32, -50176, s41
    v_mfma_f32_16x16x32_bf16 v[88:91], v[60:63], v[180:183], v[88:91]
    ds_read_b128 v[60:63], v4 offset:19136
    s_cselect_b32 s7, 0, s7
    s_waitcnt lgkmcnt(5)
    v_mfma_f32_16x16x32_bf16 v[96:99], v[40:43], v[112:115], 0
    s_cmp_eq_u32 s7, 50176
    v_mfma_f32_16x16x32_bf16 v[100:103], v[40:43], v[116:119], 0
    s_cselect_b32 s32, -50176, s41
    v_mfma_f32_16x16x32_bf16 v[104:107], v[40:43], v[120:123], 0
    s_waitcnt lgkmcnt(4)
    v_mfma_f32_16x16x32_bf16 v[96:99], v[44:47], v[124:127], v[96:99]
    v_cvt_pk_bf16_f32 v20, v80, v81
    v_mfma_f32_16x16x32_bf16 v[100:103], v[44:47], v[128:131], v[100:103]
    v_cvt_pk_bf16_f32 v21, v82, v83
    v_mfma_f32_16x16x32_bf16 v[104:107], v[44:47], v[132:135], v[104:107]
    v_cvt_pk_bf16_f32 v28, v84, v85
    s_waitcnt lgkmcnt(0)
    s_barrier
    ds_read_b128 v[40:43], v5 offset:0
    ds_read_b128 v[44:47], v5 offset:4096
    v_mfma_f32_16x16x32_bf16 v[96:99], v[48:51], v[136:139], v[96:99]
    v_cvt_pk_bf16_f32 v29, v86, v87
    v_mfma_f32_16x16x32_bf16 v[100:103], v[48:51], v[140:143], v[100:103]
    v_cvt_pk_bf16_f32 v36, v88, v89
    v_mfma_f32_16x16x32_bf16 v[104:107], v[48:51], v[144:147], v[104:107]
    ds_read_b128 v[48:51], v5 offset:8192
    v_cvt_pk_bf16_f32 v37, v90, v91
    v_mfma_f32_16x16x32_bf16 v[96:99], v[52:55], v[148:151], v[96:99]
    v_mfma_f32_16x16x32_bf16 v[100:103], v[52:55], v[152:155], v[100:103]
    v_mfma_f32_16x16x32_bf16 v[104:107], v[52:55], v[156:159], v[104:107]
    ds_read_b128 v[52:55], v5 offset:12288
    v_mfma_f32_16x16x32_bf16 v[96:99], v[56:59], v[160:163], v[96:99]
    v_mfma_f32_16x16x32_bf16 v[100:103], v[56:59], v[164:167], v[100:103]
    v_mfma_f32_16x16x32_bf16 v[104:107], v[56:59], v[168:171], v[104:107]
    ds_read_b128 v[56:59], v5 offset:16384
    v_mfma_f32_16x16x32_bf16 v[96:99], v[60:63], v[172:175], v[96:99]
    v_mfma_f32_16x16x32_bf16 v[100:103], v[60:63], v[176:179], v[100:103]
    v_mfma_f32_16x16x32_bf16 v[104:107], v[60:63], v[180:183], v[104:107]
    ds_read_b128 v[60:63], v5 offset:20480
L_B_PROJ:
    s_waitcnt lgkmcnt(5)
    v_mfma_f32_16x16x32_bf16 v[80:83], v[184:187], v[40:43], 0
    v_mfma_f32_16x16x32_bf16 v[84:87], v[188:191], v[40:43], 0
    v_mfma_f32_16x16x32_bf16 v[88:91], v[192:195], v[40:43], 0
    ds_read_b128 v[40:43], v5 offset:1024
    s_waitcnt lgkmcnt(5)
    v_mfma_f32_16x16x32_bf16 v[80:83], v[196:199], v[44:47], v[80:83]
    v_cvt_pk_bf16_f32 v22, v96, v97
    v_mfma_f32_16x16x32_bf16 v[84:87], v[200:203], v[44:47], v[84:87]
    v_cvt_pk_bf16_f32 v23, v98, v99
    v_mfma_f32_16x16x32_bf16 v[88:91], v[204:207], v[44:47], v[88:91]
    ds_read_b128 v[44:47], v5 offset:5120
    v_cvt_pk_bf16_f32 v30, v100, v101
    s_waitcnt lgkmcnt(5)
    v_mfma_f32_16x16x32_bf16 v[80:83], v[208:211], v[48:51], v[80:83]
    v_cvt_pk_bf16_f32 v31, v102, v103
    v_mfma_f32_16x16x32_bf16 v[84:87], v[212:215], v[48:51], v[84:87]
    v_cvt_pk_bf16_f32 v38, v104, v105
    v_mfma_f32_16x16x32_bf16 v[88:91], v[216:219], v[48:51], v[88:91]
    ds_read_b128 v[48:51], v5 offset:9216
    v_cvt_pk_bf16_f32 v39, v106, v107
    s_waitcnt lgkmcnt(5)
    v_mfma_f32_16x16x32_bf16 v[80:83], v[220:223], v[52:55], v[80:83]
    v_mfma_f32_16x16x32_bf16 v[84:87], v[224:227], v[52:55], v[84:87]
    v_mfma_f32_16x16x32_bf16 v[88:91], v[228:231], v[52:55], v[88:91]
    ds_read_b128 v[52:55], v5 offset:13312
    v_add_u32 v4, s32, v4
    s_waitcnt lgkmcnt(5)
    v_mfma_f32_16x16x32_bf16 v[80:83], v[232:235], v[56:59], v[80:83]
    v_mfma_f32_16x16x32_bf16 v[84:87], v[236:239], v[56:59], v[84:87]
    v_mfma_f32_16x16x32_bf16 v[88:91], v[240:243], v[56:59], v[88:91]
    ds_read_b128 v[56:59], v5 offset:17408
    s_waitcnt lgkmcnt(5)
    v_mfma_f32_16x16x32_bf16 v[80:83], v[244:247], v[60:63], v[80:83]
    v_mfma_f32_16x16x32_bf16 v[84:87], v[248:251], v[60:63], v[84:87]
    v_mfma_f32_16x16x32_bf16 v[88:91], v[252:255], v[60:63], v[88:91]
    ds_read_b128 v[60:63], v5 offset:21504
    s_waitcnt lgkmcnt(5)
    v_mfma_f32_16x16x32_bf16 v[96:99], v[184:187], v[40:43], 0
    v_mfma_f32_16x16x32_bf16 v[100:103], v[188:191], v[40:43], 0
    v_mfma_f32_16x16x32_bf16 v[104:107], v[192:195], v[40:43], 0
    ds_read_b128 v[40:43], v5 offset:2048
    s_waitcnt lgkmcnt(5)
    v_mfma_f32_16x16x32_bf16 v[96:99], v[196:199], v[44:47], v[96:99]
    v_cvt_pk_bf16_f32 v80, v80, v81
    v_mfma_f32_16x16x32_bf16 v[100:103], v[200:203], v[44:47], v[100:103]
    v_cvt_pk_bf16_f32 v81, v82, v83
    v_mfma_f32_16x16x32_bf16 v[104:107], v[204:207], v[44:47], v[104:107]
    ds_read_b128 v[44:47], v5 offset:6144
    v_cvt_pk_bf16_f32 v82, v84, v85
    s_waitcnt lgkmcnt(5)
    v_mfma_f32_16x16x32_bf16 v[96:99], v[208:211], v[48:51], v[96:99]
    v_mfma_f32_16x16x32_bf16 v[100:103], v[212:215], v[48:51], v[100:103]
    v_cvt_pk_bf16_f32 v83, v86, v87
    v_mfma_f32_16x16x32_bf16 v[104:107], v[216:219], v[48:51], v[104:107]
    ds_read_b128 v[48:51], v5 offset:10240
    ds_write_b128 v9, v[80:83] offset:0
    s_waitcnt lgkmcnt(6)
    v_mfma_f32_16x16x32_bf16 v[96:99], v[220:223], v[52:55], v[96:99]
    v_cvt_pk_bf16_f32 v84, v88, v89
    v_mfma_f32_16x16x32_bf16 v[100:103], v[224:227], v[52:55], v[100:103]
    v_mfma_f32_16x16x32_bf16 v[104:107], v[228:231], v[52:55], v[104:107]
    ds_read_b128 v[52:55], v5 offset:14336
    v_cvt_pk_bf16_f32 v85, v90, v91
    s_waitcnt lgkmcnt(6)
    v_mfma_f32_16x16x32_bf16 v[96:99], v[232:235], v[56:59], v[96:99]
    ds_write_b64 v10, v[84:85] offset:0
    v_mfma_f32_16x16x32_bf16 v[100:103], v[236:239], v[56:59], v[100:103]
    v_mfma_f32_16x16x32_bf16 v[104:107], v[240:243], v[56:59], v[104:107]
    ds_read_b128 v[56:59], v5 offset:18432
    s_waitcnt lgkmcnt(7)
    v_mfma_f32_16x16x32_bf16 v[96:99], v[244:247], v[60:63], v[96:99]
    v_mfma_f32_16x16x32_bf16 v[100:103], v[248:251], v[60:63], v[100:103]
    v_mfma_f32_16x16x32_bf16 v[104:107], v[252:255], v[60:63], v[104:107]
    ds_read_b128 v[60:63], v5 offset:22528
    s_waitcnt lgkmcnt(7)
    v_mfma_f32_16x16x32_bf16 v[80:83], v[184:187], v[40:43], 0
    v_mfma_f32_16x16x32_bf16 v[84:87], v[188:191], v[40:43], 0
    v_mfma_f32_16x16x32_bf16 v[88:91], v[192:195], v[40:43], 0
    ds_read_b128 v[40:43], v5 offset:3072
    s_waitcnt lgkmcnt(7)
    v_mfma_f32_16x16x32_bf16 v[80:83], v[196:199], v[44:47], v[80:83]
    v_cvt_pk_bf16_f32 v96, v96, v97
    v_mfma_f32_16x16x32_bf16 v[84:87], v[200:203], v[44:47], v[84:87]
    v_cvt_pk_bf16_f32 v97, v98, v99
    v_mfma_f32_16x16x32_bf16 v[88:91], v[204:207], v[44:47], v[88:91]
    ds_read_b128 v[44:47], v5 offset:7168
    v_cvt_pk_bf16_f32 v98, v100, v101
    s_waitcnt lgkmcnt(7)
    v_mfma_f32_16x16x32_bf16 v[80:83], v[208:211], v[48:51], v[80:83]
    v_mfma_f32_16x16x32_bf16 v[84:87], v[212:215], v[48:51], v[84:87]
    v_cvt_pk_bf16_f32 v99, v102, v103
    v_mfma_f32_16x16x32_bf16 v[88:91], v[216:219], v[48:51], v[88:91]
    ds_read_b128 v[48:51], v5 offset:11264
    ds_write_b128 v9, v[96:99] offset:6272
    s_waitcnt lgkmcnt(7)
    v_mfma_f32_16x16x32_bf16 v[80:83], v[220:223], v[52:55], v[80:83]
    v_cvt_pk_bf16_f32 v100, v104, v105
    v_mfma_f32_16x16x32_bf16 v[84:87], v[224:227], v[52:55], v[84:87]
    v_mfma_f32_16x16x32_bf16 v[88:91], v[228:231], v[52:55], v[88:91]
    ds_read_b128 v[52:55], v5 offset:15360
    v_cvt_pk_bf16_f32 v101, v106, v107
    s_waitcnt lgkmcnt(6)
    v_mfma_f32_16x16x32_bf16 v[80:83], v[232:235], v[56:59], v[80:83]
    ds_write_b64 v10, v[100:101] offset:6272
    v_mfma_f32_16x16x32_bf16 v[84:87], v[236:239], v[56:59], v[84:87]
    v_mfma_f32_16x16x32_bf16 v[88:91], v[240:243], v[56:59], v[88:91]
    ds_read_b128 v[56:59], v5 offset:19456
    s_waitcnt lgkmcnt(7)
    v_mfma_f32_16x16x32_bf16 v[80:83], v[244:247], v[60:63], v[80:83]
    v_mfma_f32_16x16x32_bf16 v[84:87], v[248:251], v[60:63], v[84:87]
    v_mfma_f32_16x16x32_bf16 v[88:91], v[252:255], v[60:63], v[88:91]
    ds_read_b128 v[60:63], v5 offset:23552
    s_waitcnt lgkmcnt(7)
    v_mfma_f32_16x16x32_bf16 v[96:99], v[184:187], v[40:43], 0
    v_mfma_f32_16x16x32_bf16 v[100:103], v[188:191], v[40:43], 0
    v_mfma_f32_16x16x32_bf16 v[104:107], v[192:195], v[40:43], 0
    ds_read_b128 v[40:43], v4 offset:0
    s_waitcnt lgkmcnt(7)
    v_mfma_f32_16x16x32_bf16 v[96:99], v[196:199], v[44:47], v[96:99]
    v_cvt_pk_bf16_f32 v80, v80, v81
    v_mfma_f32_16x16x32_bf16 v[100:103], v[200:203], v[44:47], v[100:103]
    v_cvt_pk_bf16_f32 v81, v82, v83
    v_mfma_f32_16x16x32_bf16 v[104:107], v[204:207], v[44:47], v[104:107]
    ds_read_b128 v[44:47], v4 offset:64
    v_cvt_pk_bf16_f32 v82, v84, v85
    s_waitcnt lgkmcnt(7)
    v_mfma_f32_16x16x32_bf16 v[96:99], v[208:211], v[48:51], v[96:99]
    v_mfma_f32_16x16x32_bf16 v[100:103], v[212:215], v[48:51], v[100:103]
    v_cvt_pk_bf16_f32 v83, v86, v87
    v_mfma_f32_16x16x32_bf16 v[104:107], v[216:219], v[48:51], v[104:107]
    ds_read_b128 v[48:51], v4 offset:128
    ds_write_b128 v9, v[80:83] offset:12544
    s_waitcnt lgkmcnt(7)
    v_mfma_f32_16x16x32_bf16 v[96:99], v[220:223], v[52:55], v[96:99]
    v_cvt_pk_bf16_f32 v84, v88, v89
    v_mfma_f32_16x16x32_bf16 v[100:103], v[224:227], v[52:55], v[100:103]
    v_mfma_f32_16x16x32_bf16 v[104:107], v[228:231], v[52:55], v[104:107]
    ds_read_b128 v[52:55], v4 offset:192
    v_cvt_pk_bf16_f32 v85, v90, v91
    s_waitcnt lgkmcnt(6)
    v_mfma_f32_16x16x32_bf16 v[96:99], v[232:235], v[56:59], v[96:99]
    ds_write_b64 v10, v[84:85] offset:12544
    v_mfma_f32_16x16x32_bf16 v[100:103], v[236:239], v[56:59], v[100:103]
    v_mfma_f32_16x16x32_bf16 v[104:107], v[240:243], v[56:59], v[104:107]
    ds_read_b128 v[56:59], v4 offset:256
    s_waitcnt lgkmcnt(7)
    v_mfma_f32_16x16x32_bf16 v[96:99], v[244:247], v[60:63], v[96:99]
    v_mfma_f32_16x16x32_bf16 v[100:103], v[248:251], v[60:63], v[100:103]
    v_mfma_f32_16x16x32_bf16 v[104:107], v[252:255], v[60:63], v[104:107]
    ds_read_b128 v[60:63], v4 offset:320
    s_add_u32 s5, s5, 1
    s_cmp_gt_u32 s5, 9
    v_cvt_pk_bf16_f32 v96, v96, v97
    v_cvt_pk_bf16_f32 v97, v98, v99
    v_cvt_pk_bf16_f32 v98, v100, v101
    v_cvt_pk_bf16_f32 v99, v102, v103
    ds_write_b128 v9, v[96:99] offset:18816
    v_cvt_pk_bf16_f32 v100, v104, v105
    v_cvt_pk_bf16_f32 v101, v106, v107
    ds_write_b64 v10, v[100:101] offset:18816
    s_waitcnt lgkmcnt(0)
    s_cbranch_scc1 L_B_FIN
    s_waitcnt vmcnt(0)
    s_barrier
    s_branch L_B_LOOP
L_B_TAIL:
    v_add_u32 v9, s32, v9
    v_add_u32 v10, s32, v10
    s_mov_b32 s32, 0
    s_add_u32 s31, s33, s7
    s_sub_u32 s31, s31, 75264
    v_add_u32 v11, s31, v5
    s_add_u32 s31, s35, 294912
    s_nop 4
    v_rcp_f32 v108, v108
    s_nop 0
    v_mul_f32 v96, v96, v108
    v_mul_f32 v97, v97, v108
    v_mul_f32 v98, v98, v108
    v_mul_f32 v99, v99, v108
    v_cvt_pk_bf16_f32 v96, v96, v97
    v_cvt_pk_bf16_f32 v97, v98, v99
    v_mul_f32 v100, v100, v108
    v_mul_f32 v101, v101, v108
    v_mul_f32 v102, v102, v108
    v_mul_f32 v103, v103, v108
    v_cvt_pk_bf16_f32 v98, v100, v101
    v_cvt_pk_bf16_f32 v99, v102, v103
    v_mul_f32 v104, v104, v108
    ds_write_b128 v6, v[96:99] offset:3072
    v_mul_f32 v105, v105, v108
    v_mul_f32 v106, v106, v108
    v_mul_f32 v107, v107, v108
    v_cvt_pk_bf16_f32 v100, v104, v105
    v_cvt_pk_bf16_f32 v101, v106, v107
    ds_write_b64 v7, v[100:101] offset:3072
    ds_read_b128 v[40:43], v11 offset:0
    ds_read_b128 v[44:47], v11 offset:1024
    ds_read_b128 v[48:51], v11 offset:2048
    ds_read_b128 v[52:55], v11 offset:3136
    ds_read_b128 v[56:59], v11 offset:4160
    ds_read_b128 v[60:63], v11 offset:5184
    s_waitcnt lgkmcnt(0)
    s_barrier
    buffer_store_dwordx4 v[40:43], v1, s[12:15], s35 offen offset:0 sc0 sc1
    buffer_store_dwordx4 v[44:47], v2, s[12:15], s35 offen offset:1024 sc0 sc1
    buffer_store_dwordx4 v[48:51], v3, s[12:15], s35 offen offset:2048 sc0 sc1
    buffer_store_dwordx4 v[52:55], v1, s[12:15], s31 offen offset:0 sc0 sc1
    buffer_store_dwordx4 v[56:59], v2, s[12:15], s31 offen offset:1024 sc0 sc1
    buffer_store_dwordx4 v[60:63], v3, s[12:15], s31 offen offset:2048 sc0 sc1
    s_mov_b32 s35, s36
    s_mov_b32 s36, s37
    s_mov_b32 s37, s38
    s_mov_b32 s7, 0
    ds_read_b128 v[40:43], v5 offset:0
    ds_read_b128 v[44:47], v5 offset:4096
    ds_read_b128 v[48:51], v5 offset:8192
    ds_read_b128 v[52:55], v5 offset:12288
    ds_read_b128 v[56:59], v5 offset:16384
    ds_read_b128 v[60:63], v5 offset:20480
    s_waitcnt lgkmcnt(0)
    s_branch L_B_PROJ
L_B_B9:
    s_waitcnt vmcnt(0)
    s_barrier
    s_branch L_B_B9R
L_B_FIN:
    s_add_u32 s31, s33, s7
    s_sub_u32 s31, s31, 75264
    v_add_u32 v11, s31, v5
    s_add_u32 s31, s35, 294912
    s_barrier
    ds_read_b128 v[40:43], v11 offset:0
    ds_read_b128 v[44:47], v11 offset:1024
    ds_read_b128 v[48:51], v11 offset:2048
    ds_read_b128 v[52:55], v11 offset:3136
    ds_read_b128 v[56:59], v11 offset:4160
    ds_read_b128 v[60:63], v11 offset:5184
    s_waitcnt lgkmcnt(5)
    buffer_store_dwordx4 v[40:43], v1, s[12:15], s35 offen offset:0 sc0 sc1
    s_waitcnt lgkmcnt(4)
    buffer_store_dwordx4 v[44:47], v2, s[12:15], s35 offen offset:1024 sc0 sc1
    s_waitcnt lgkmcnt(3)
    buffer_store_dwordx4 v[48:51], v3, s[12:15], s35 offen offset:2048 sc0 sc1
    s_waitcnt lgkmcnt(2)
    buffer_store_dwordx4 v[52:55], v1, s[12:15], s31 offen offset:0 sc0 sc1
    s_waitcnt lgkmcnt(1)
    buffer_store_dwordx4 v[56:59], v2, s[12:15], s31 offen offset:1024 sc0 sc1
    s_waitcnt lgkmcnt(0)
    buffer_store_dwordx4 v[60:63], v3, s[12:15], s31 offen offset:2048 sc0 sc1
L_END:
s_endpgm
.section .rodata,"a"
.p2align 6
.amdhsa_kernel standalone__window_attn_swin__vision_kernel
  .amdhsa_next_free_vgpr 256
  .amdhsa_next_free_sgpr 102
  .amdhsa_accum_offset 256
  .amdhsa_group_segment_fixed_size 0
  .amdhsa_kernarg_size 72
  .amdhsa_user_sgpr_count 2
  .amdhsa_user_sgpr_kernarg_segment_ptr 1
  .amdhsa_system_sgpr_workgroup_id_x 1
.end_amdhsa_kernel
```
